```python
import torch

def _softmax(x, axis=-1):
    return torch.softmax(x, dim=axis)
def _gelu(x):
    return torch.nn.functional.gelu(x, approximate="tanh")
def _silu(x):
    return torch.nn.functional.silu(x)
def _sigmoid(x):
    return torch.sigmoid(x)
def _layernorm(x, axis=-1, eps=1e-5):
    m = x.mean(dim=axis, keepdim=True)
    v = x.var(dim=axis, keepdim=True, unbiased=False)
    return (x - m) / torch.sqrt(v + eps)
def _scatter_add(tgt, idx, src, axis=0):
    return tgt.clone().index_add_(axis, idx, src)
def _segment_sum(src, seg, n):
    out = torch.zeros((n,) + src.shape[1:], dtype=src.dtype)
    return out.index_add_(0, seg, src)
def _pad(x, pw):
    flat = tuple(v for pair in reversed(pw) for v in pair)
    return torch.nn.functional.pad(x, flat)

kernel_name = 'standalone__mha_softmax__near_ridge'

def setup_inputs():

    _w = (lambda a: (lambda t: t.to(torch.bfloat16) if t.is_floating_point() else t)(torch.as_tensor(a)))
    B, H, Sq, Sk, D = 8, 32, 368, 512, 128
    return {
        "q": _w((lambda *s: torch.randn(*s, dtype=torch.bfloat16) * 0.8)(B, H, Sq, D)),
        "k": _w((lambda *s: torch.randn(*s, dtype=torch.bfloat16) * 0.8)(B, H, Sk, D)),
        "v": _w((lambda *s: torch.randn(*s, dtype=torch.bfloat16) * 0.05)(B, H, Sk, D)),
    }

def reference(q, k, v):
    scale = q.shape[-1] ** -0.5
    scores = torch.einsum("bhqd,bhkd->bhqk", q, k) * scale
    p = _softmax(scores, axis=-1)
    return torch.einsum("bhqk,bhkd->bhqd", p, v)
```

```asm
; @launch grid=(256,1,1) block=(256,1,1) lds=163840
.amdgcn_target "amdgcn-amd-amdhsa--gfx950"
.text
.globl standalone__mha_softmax__near_ridge_kernel
.p2align 8
.type standalone__mha_softmax__near_ridge_kernel,@function
standalone__mha_softmax__near_ridge_kernel:
    s_load_dwordx8 s[4:11], s[0:1], 0
    s_cmp_ge_u32 s2, 256
    s_cbranch_scc1 L_end
    s_getpc_b64 s[50:51]
    v_lshlrev_b32 v25, 7, v0
    v_min_u32 v25, 22308, v25
    global_load_dword v26, v25, s[50:51]
    v_and_b32 v1, 63, v0
    v_lshrrev_b32 v27, 6, v0
    v_lshrrev_b32 v28, 4, v1
    v_and_b32 v29, 15, v1
    v_xor_b32 v21, v28, v29
    v_lshlrev_b32 v20, 8, v28
    v_lshl_add_u32 v24, v21, 4, v20
    v_lshl_add_u32 v2, v27, 11, v24
    v_mul_u32_u24 v22, 24576, v27
    v_add_u32 v14, v22, v24
    v_lshlrev_b32 v20, 11, v28
    v_lshl_add_u32 v20, v27, 9, v20
    v_lshl_add_u32 v3, v29, 4, v20
    v_readfirstlane_b32 s32, v27
    s_mul_i32 s45, s2, 94208
    s_lshl_b32 s46, s2, 17
    s_mov_b32 s23, 0x20000
    s_mov_b32 s22, s23
    s_mov_b32 s19, s23
    s_mov_b32 s18, 94208
    s_mul_i32 s42, s32, 2176
    s_mul_i32 s53, s32, 8704
    s_add_u32 s52, s53, 34816
    s_mov_b32 s3, 0
    s_mov_b64 s[100:101], 0
    s_waitcnt lgkmcnt(0)
    s_add_u32 s16, s4, s45
    s_addc_u32 s17, s5, 0
    s_add_u32 s20, s6, s46
    s_addc_u32 s21, s7, 0
L_restart:
    s_add_u32 m0, s52, 0
    s_nop 0
    buffer_load_dwordx4 v14, s[16:19], 0 offen offset:0 nt lds
    s_add_u32 m0, s52, 64
    s_nop 0
    buffer_load_dwordx4 v14, s[16:19], 0 offen offset:1024 nt lds
    s_add_u32 m0, s52, 128
    s_nop 0
    buffer_load_dwordx4 v14, s[16:19], 0 offen offset:2048 nt lds
    s_add_u32 m0, s52, 192
    s_nop 0
    buffer_load_dwordx4 v14, s[16:19], 0 offen offset:3072 nt lds
    s_add_u32 m0, s42, 0
    s_mov_b32 s47, 0
    buffer_load_dwordx4 v2, s[20:23], s47 offen offset:0 nt lds
    s_add_u32 m0, s42, 64
    s_nop 0
    buffer_load_dwordx4 v2, s[20:23], s47 offen offset:1024 nt lds
    s_add_u32 m0, s42, 8704
    s_mov_b32 s47, 8192
    buffer_load_dwordx4 v2, s[20:23], s47 offen offset:0 nt lds
    s_add_u32 m0, s42, 8768
    s_nop 0
    buffer_load_dwordx4 v2, s[20:23], s47 offen offset:1024 nt lds
    v_add_u32 v23, 4096, v14
    s_add_u32 m0, s52, 4352
    s_nop 0
    buffer_load_dwordx4 v23, s[16:19], 0 offen offset:0 nt lds
    s_add_u32 m0, s52, 4416
    s_nop 0
    buffer_load_dwordx4 v23, s[16:19], 0 offen offset:1024 nt lds
    s_add_u32 m0, s52, 4480
    s_nop 0
    buffer_load_dwordx4 v23, s[16:19], 0 offen offset:2048 nt lds
    s_add_u32 m0, s52, 4544
    s_nop 0
    buffer_load_dwordx4 v23, s[16:19], 0 offen offset:3072 nt lds
    s_mov_b32 s44, s23
    s_mov_b32 s26, s23
    s_mov_b32 s27, s23
    s_mov_b32 s31, s23
    s_mov_b32 s30, s18
    s_add_u32 s24, s8, s46
    s_addc_u32 s25, s9, 0
    s_add_u32 s28, s10, s45
    s_addc_u32 s29, s11, 0
    s_mul_i32 s43, s32, 2112
    s_add_u32 s43, s43, 69632
    s_add_u32 s54, s52, 86528
    s_add_u32 s53, s52, 51712
    v_lshrrev_b32 v20, 2, v29
    v_mul_u32_u24 v20, 1088, v20
    v_and_b32 v21, 3, v29
    v_lshl_add_u32 v20, v21, 8, v20
    v_xor_b32 v21, v21, v28
    v_lshl_add_u32 v4, v21, 4, v20
    v_bfe_u32 v20, v1, 2, 3
    v_mul_u32_u24 v20, 1056, v20
    v_lshrrev_b32 v21, 5, v1
    v_lshl_add_u32 v20, v21, 8, v20
    v_and_b32 v21, 3, v1
    v_lshl_add_u32 v20, v21, 3, v20
    v_add_u32 v5, 69632, v20
    v_mov_b32 v6, v4
    v_mov_b32 v7, v5
    s_mul_i32 s56, s32, 4352
    s_add_u32 s56, s56, 137216
    v_mul_u32_u24 v20, 272, v29
    v_lshl_add_u32 v20, v28, 3, v20
    v_add_u32 v15, s56, v20
    v_mul_u32_u24 v20, 272, v28
    v_lshl_add_u32 v20, v29, 4, v20
    v_add_u32 v16, s56, v20
    v_lshl_add_u32 v17, v1, 4, v22
    v_cmp_eq_u32 vcc, 0, v21
    v_mov_b32 v30, 0x3f803f80
    s_mov_b32 s34, 0x3e0293ee
    v_cndmask_b32 v28, 0, v30, vcc
    v_mov_b32 v29, v28
    v_mov_b32 v30, v28
    v_mov_b32 v31, v28
    s_add_u32 s48, s42, 69632
    s_add_u32 s49, s43, 67584
    s_cmp_eq_u32 s32, 3
    s_cselect_b32 s55, 0xff7fffff, 0
    s_waitcnt vmcnt(8)
    v_add_u32 v20, s52, v4
    ds_read_b128 v[224:227], v20 offset:0
    ds_read_b128 v[228:231], v20 offset:64
    ds_read_b128 v[232:235], v20 offset:128
    ds_read_b128 v[236:239], v20 offset:192
    v_add_u32 v23, 8192, v14
    s_add_u32 m0, s53, 0
    s_nop 0
    buffer_load_dwordx4 v23, s[16:19], 0 offen offset:0 nt lds
    s_add_u32 m0, s53, 64
    s_nop 0
    buffer_load_dwordx4 v23, s[16:19], 0 offen offset:1024 nt lds
    s_add_u32 m0, s53, 128
    s_nop 0
    buffer_load_dwordx4 v23, s[16:19], 0 offen offset:2048 nt lds
    s_add_u32 m0, s53, 192
    s_nop 0
    buffer_load_dwordx4 v23, s[16:19], 0 offen offset:3072 nt lds
    s_waitcnt lgkmcnt(3)
    v_lshlrev_b32 v240, 16, v224
    v_and_b32 v241, 0xffff0000, v224
    v_lshlrev_b32 v242, 16, v225
    v_and_b32 v243, 0xffff0000, v225
    v_lshlrev_b32 v244, 16, v226
    v_and_b32 v245, 0xffff0000, v226
    v_lshlrev_b32 v246, 16, v227
    v_and_b32 v247, 0xffff0000, v227
    v_pk_mul_f32 v[240:241], v[240:241], s[34:35] op_sel_hi:[1,0]
    v_pk_mul_f32 v[242:243], v[242:243], s[34:35] op_sel_hi:[1,0]
    v_pk_mul_f32 v[244:245], v[244:245], s[34:35] op_sel_hi:[1,0]
    v_pk_mul_f32 v[246:247], v[246:247], s[34:35] op_sel_hi:[1,0]
    v_cvt_pk_bf16_f32 v224, v240, v241
    v_cvt_pk_bf16_f32 v225, v242, v243
    v_cvt_pk_bf16_f32 v226, v244, v245
    v_cvt_pk_bf16_f32 v227, v246, v247
    s_waitcnt lgkmcnt(2)
    v_lshlrev_b32 v240, 16, v228
    v_and_b32 v241, 0xffff0000, v228
    v_lshlrev_b32 v242, 16, v229
    v_and_b32 v243, 0xffff0000, v229
    v_lshlrev_b32 v244, 16, v230
    v_and_b32 v245, 0xffff0000, v230
    v_lshlrev_b32 v246, 16, v231
    v_and_b32 v247, 0xffff0000, v231
    v_pk_mul_f32 v[240:241], v[240:241], s[34:35] op_sel_hi:[1,0]
    v_pk_mul_f32 v[242:243], v[242:243], s[34:35] op_sel_hi:[1,0]
    v_pk_mul_f32 v[244:245], v[244:245], s[34:35] op_sel_hi:[1,0]
    v_pk_mul_f32 v[246:247], v[246:247], s[34:35] op_sel_hi:[1,0]
    v_cvt_pk_bf16_f32 v228, v240, v241
    v_cvt_pk_bf16_f32 v229, v242, v243
    v_cvt_pk_bf16_f32 v230, v244, v245
    v_cvt_pk_bf16_f32 v231, v246, v247
    s_waitcnt lgkmcnt(1)
    v_lshlrev_b32 v240, 16, v232
    v_and_b32 v241, 0xffff0000, v232
    v_lshlrev_b32 v242, 16, v233
    v_and_b32 v243, 0xffff0000, v233
    v_lshlrev_b32 v244, 16, v234
    v_and_b32 v245, 0xffff0000, v234
    v_lshlrev_b32 v246, 16, v235
    v_and_b32 v247, 0xffff0000, v235
    v_pk_mul_f32 v[240:241], v[240:241], s[34:35] op_sel_hi:[1,0]
    v_pk_mul_f32 v[242:243], v[242:243], s[34:35] op_sel_hi:[1,0]
    v_pk_mul_f32 v[244:245], v[244:245], s[34:35] op_sel_hi:[1,0]
    v_pk_mul_f32 v[246:247], v[246:247], s[34:35] op_sel_hi:[1,0]
    v_cvt_pk_bf16_f32 v232, v240, v241
    v_cvt_pk_bf16_f32 v233, v242, v243
    v_cvt_pk_bf16_f32 v234, v244, v245
    v_cvt_pk_bf16_f32 v235, v246, v247
    s_waitcnt lgkmcnt(0)
    v_lshlrev_b32 v240, 16, v236
    v_and_b32 v241, 0xffff0000, v236
    v_lshlrev_b32 v242, 16, v237
    v_and_b32 v243, 0xffff0000, v237
    v_lshlrev_b32 v244, 16, v238
    v_and_b32 v245, 0xffff0000, v238
    v_lshlrev_b32 v246, 16, v239
    v_and_b32 v247, 0xffff0000, v239
    v_pk_mul_f32 v[240:241], v[240:241], s[34:35] op_sel_hi:[1,0]
    v_pk_mul_f32 v[242:243], v[242:243], s[34:35] op_sel_hi:[1,0]
    v_pk_mul_f32 v[244:245], v[244:245], s[34:35] op_sel_hi:[1,0]
    v_pk_mul_f32 v[246:247], v[246:247], s[34:35] op_sel_hi:[1,0]
    v_cvt_pk_bf16_f32 v236, v240, v241
    v_cvt_pk_bf16_f32 v237, v242, v243
    v_cvt_pk_bf16_f32 v238, v244, v245
    v_cvt_pk_bf16_f32 v239, v246, v247
    s_waitcnt vmcnt(8)
    s_barrier
    ds_read_b128 a[192:195], v4 offset:0
    ds_read_b128 a[196:199], v4 offset:64
    ds_read_b128 a[200:203], v4 offset:128
    ds_read_b128 a[204:207], v4 offset:192
    ds_read_b128 a[208:211], v4 offset:4352
    ds_read_b128 a[212:215], v4 offset:4416
    ds_read_b128 a[216:219], v4 offset:4480
    ds_read_b128 a[220:223], v4 offset:4544
    ds_read_b128 a[224:227], v4 offset:8704
    ds_read_b128 a[228:231], v4 offset:8768
    ds_read_b128 a[232:235], v4 offset:8832
    ds_read_b128 a[236:239], v4 offset:8896
    s_waitcnt lgkmcnt(4)
    ds_read_b128 a[240:243], v4 offset:13056
    ds_read_b128 a[244:247], v4 offset:13120
    ds_read_b128 a[248:251], v4 offset:13184
    ds_read_b128 a[252:255], v4 offset:13248
    v_add_u32 v23, 12288, v14
    s_nop 1
    v_mfma_f32_16x16x32_bf16 v[240:243], a[192:195], v[224:227], 0
    s_add_u32 m0, s53, 4352
    v_accvgpr_write_b32 a96, v224
    v_mfma_f32_16x16x32_bf16 v[240:243], a[196:199], v[228:231], v[240:243]
    buffer_load_dwordx4 v23, s[16:19], 0 offen offset:0 nt lds
    v_accvgpr_write_b32 a97, v225
    v_mfma_f32_16x16x32_bf16 v[240:243], a[200:203], v[232:235], v[240:243]
    s_add_u32 m0, s53, 4416
    v_accvgpr_write_b32 a98, v226
    v_mfma_f32_16x16x32_bf16 v[240:243], a[204:207], v[236:239], v[240:243]
    buffer_load_dwordx4 v23, s[16:19], 0 offen offset:1024 nt lds
    v_accvgpr_write_b32 a99, v227
    v_mfma_f32_16x16x32_bf16 v[244:247], a[208:211], v[224:227], 0
    s_add_u32 m0, s53, 4480
    v_accvgpr_write_b32 a100, v228
    v_mfma_f32_16x16x32_bf16 v[244:247], a[212:215], v[228:231], v[244:247]
    buffer_load_dwordx4 v23, s[16:19], 0 offen offset:2048 nt lds
    v_accvgpr_write_b32 a101, v229
    v_mfma_f32_16x16x32_bf16 v[244:247], a[216:219], v[232:235], v[244:247]
    s_add_u32 m0, s53, 4544
    v_accvgpr_write_b32 a102, v230
    v_mfma_f32_16x16x32_bf16 v[244:247], a[220:223], v[236:239], v[244:247]
    buffer_load_dwordx4 v23, s[16:19], 0 offen offset:3072 nt lds
    v_accvgpr_write_b32 a103, v231
    s_waitcnt lgkmcnt(0)
    v_mfma_f32_16x16x32_bf16 v[128:131], a[224:227], v[224:227], 0
    v_accvgpr_write_b32 a104, v232
    v_mfma_f32_16x16x32_bf16 v[128:131], a[228:231], v[228:231], v[128:131]
    v_accvgpr_write_b32 a105, v233
    v_mfma_f32_16x16x32_bf16 v[128:131], a[232:235], v[232:235], v[128:131]
    v_accvgpr_write_b32 a106, v234
    v_mfma_f32_16x16x32_bf16 v[128:131], a[236:239], v[236:239], v[128:131]
    v_accvgpr_write_b32 a107, v235
    v_max3_f32 v20, v240, v240, v241
    v_mfma_f32_16x16x32_bf16 v[132:135], a[240:243], v[224:227], 0
    v_accvgpr_write_b32 a108, v236
    v_max3_f32 v20, v20, v242, v243
    v_mfma_f32_16x16x32_bf16 v[132:135], a[244:247], v[228:231], v[132:135]
    v_accvgpr_write_b32 a109, v237
    v_max3_f32 v20, v20, v244, v245
    v_mfma_f32_16x16x32_bf16 v[132:135], a[248:251], v[232:235], v[132:135]
    v_accvgpr_write_b32 a110, v238
    v_max3_f32 v20, v20, v246, v247
    v_mfma_f32_16x16x32_bf16 v[132:135], a[252:255], v[236:239], v[132:135]
    v_accvgpr_write_b32 a111, v239
    s_cmp_lg_u32 s3, 0
    s_cbranch_scc1 L_skipmax0
    v_max3_f32 v20, v20, v128, v129
    v_max3_f32 v20, v20, v130, v131
    s_nop 3
    v_max3_f32 v20, v20, v132, v133
    v_max3_f32 v20, v20, v134, v135
    v_mov_b32 v21, v20
    s_nop 1
    v_permlane16_swap_b32 v20, v21
    v_max_f32 v20, v20, v21
    v_mov_b32 v21, v20
    s_nop 1
    v_permlane32_swap_b32 v20, v21
    v_max_f32 v20, v20, v21
    v_sub_f32 v200, 0, v20
    v_mov_b32 v201, v200
    v_mov_b32 v202, v200
    v_mov_b32 v203, v200
L_skipmax0:
    v_pk_add_f32 v[240:241], v[240:241], v[200:201]
    v_pk_add_f32 v[242:243], v[242:243], v[200:201]
    v_pk_add_f32 v[244:245], v[244:245], v[200:201]
    v_pk_add_f32 v[246:247], v[246:247], v[200:201]
    v_pk_add_f32 v[128:129], v[128:129], v[200:201]
    v_pk_add_f32 v[130:131], v[130:131], v[200:201]
    v_pk_add_f32 v[132:133], v[132:133], v[200:201]
    v_pk_add_f32 v[134:135], v[134:135], v[200:201]
    v_exp_f32 v240, v240
    v_exp_f32 v241, v241
    v_exp_f32 v242, v242
    v_exp_f32 v243, v243
    v_exp_f32 v244, v244
    v_exp_f32 v245, v245
    v_exp_f32 v246, v246
    v_exp_f32 v247, v247
    v_exp_f32 v128, v128
    v_exp_f32 v129, v129
    v_exp_f32 v130, v130
    v_exp_f32 v131, v131
    v_exp_f32 v132, v132
    v_exp_f32 v133, v133
    v_exp_f32 v134, v134
    v_exp_f32 v135, v135
    s_waitcnt vmcnt(8)
    v_add_u32 v20, s52, v4
    ds_read_b128 v[224:227], v20 offset:4352
    ds_read_b128 v[228:231], v20 offset:4416
    ds_read_b128 v[232:235], v20 offset:4480
    ds_read_b128 v[236:239], v20 offset:4544
    v_cvt_pk_bf16_f32 v96, v240, v241
    v_cvt_pk_bf16_f32 v97, v242, v243
    v_cvt_pk_bf16_f32 v98, v244, v245
    v_cvt_pk_bf16_f32 v99, v246, v247
    v_add_f32 v8, v240, v241
    v_add_f32 v8, v8, v242
    v_add_f32 v8, v8, v243
    v_add_f32 v8, v8, v244
    v_add_f32 v8, v8, v245
    v_add_f32 v8, v8, v246
    v_add_f32 v8, v8, v247
    v_cvt_pk_bf16_f32 v176, v128, v129
    v_cvt_pk_bf16_f32 v177, v130, v131
    v_cvt_pk_bf16_f32 v178, v132, v133
    v_cvt_pk_bf16_f32 v179, v134, v135
    v_add_f32 v8, v8, v128
    v_add_f32 v8, v8, v129
    v_add_f32 v8, v8, v130
    v_add_f32 v8, v8, v131
    v_add_f32 v8, v8, v132
    v_add_f32 v8, v8, v133
    v_add_f32 v8, v8, v134
    v_add_f32 v8, v8, v135
    s_waitcnt lgkmcnt(3)
    v_lshlrev_b32 v240, 16, v224
    v_and_b32 v241, 0xffff0000, v224
    v_lshlrev_b32 v242, 16, v225
    v_and_b32 v243, 0xffff0000, v225
    v_lshlrev_b32 v244, 16, v226
    v_and_b32 v245, 0xffff0000, v226
    v_lshlrev_b32 v246, 16, v227
    v_and_b32 v247, 0xffff0000, v227
    v_pk_mul_f32 v[240:241], v[240:241], s[34:35] op_sel_hi:[1,0]
    v_pk_mul_f32 v[242:243], v[242:243], s[34:35] op_sel_hi:[1,0]
    v_pk_mul_f32 v[244:245], v[244:245], s[34:35] op_sel_hi:[1,0]
    v_pk_mul_f32 v[246:247], v[246:247], s[34:35] op_sel_hi:[1,0]
    v_cvt_pk_bf16_f32 v224, v240, v241
    v_cvt_pk_bf16_f32 v225, v242, v243
    v_cvt_pk_bf16_f32 v226, v244, v245
    v_cvt_pk_bf16_f32 v227, v246, v247
    s_waitcnt lgkmcnt(2)
    v_lshlrev_b32 v240, 16, v228
    v_and_b32 v241, 0xffff0000, v228
    v_lshlrev_b32 v242, 16, v229
    v_and_b32 v243, 0xffff0000, v229
    v_lshlrev_b32 v244, 16, v230
    v_and_b32 v245, 0xffff0000, v230
    v_lshlrev_b32 v246, 16, v231
    v_and_b32 v247, 0xffff0000, v231
    v_pk_mul_f32 v[240:241], v[240:241], s[34:35] op_sel_hi:[1,0]
    v_pk_mul_f32 v[242:243], v[242:243], s[34:35] op_sel_hi:[1,0]
    v_pk_mul_f32 v[244:245], v[244:245], s[34:35] op_sel_hi:[1,0]
    v_pk_mul_f32 v[246:247], v[246:247], s[34:35] op_sel_hi:[1,0]
    v_cvt_pk_bf16_f32 v228, v240, v241
    v_cvt_pk_bf16_f32 v229, v242, v243
    v_cvt_pk_bf16_f32 v230, v244, v245
    v_cvt_pk_bf16_f32 v231, v246, v247
    s_waitcnt lgkmcnt(1)
    v_lshlrev_b32 v240, 16, v232
    v_and_b32 v241, 0xffff0000, v232
    v_lshlrev_b32 v242, 16, v233
    v_and_b32 v243, 0xffff0000, v233
    v_lshlrev_b32 v244, 16, v234
    v_and_b32 v245, 0xffff0000, v234
    v_lshlrev_b32 v246, 16, v235
    v_and_b32 v247, 0xffff0000, v235
    v_pk_mul_f32 v[240:241], v[240:241], s[34:35] op_sel_hi:[1,0]
    v_pk_mul_f32 v[242:243], v[242:243], s[34:35] op_sel_hi:[1,0]
    v_pk_mul_f32 v[244:245], v[244:245], s[34:35] op_sel_hi:[1,0]
    v_pk_mul_f32 v[246:247], v[246:247], s[34:35] op_sel_hi:[1,0]
    v_cvt_pk_bf16_f32 v232, v240, v241
    v_cvt_pk_bf16_f32 v233, v242, v243
    v_cvt_pk_bf16_f32 v234, v244, v245
    v_cvt_pk_bf16_f32 v235, v246, v247
    s_waitcnt lgkmcnt(0)
    v_lshlrev_b32 v240, 16, v236
    v_and_b32 v241, 0xffff0000, v236
    v_lshlrev_b32 v242, 16, v237
    v_and_b32 v243, 0xffff0000, v237
    v_lshlrev_b32 v244, 16, v238
    v_and_b32 v245, 0xffff0000, v238
    v_lshlrev_b32 v246, 16, v239
    v_and_b32 v247, 0xffff0000, v239
    v_pk_mul_f32 v[240:241], v[240:241], s[34:35] op_sel_hi:[1,0]
    v_pk_mul_f32 v[242:243], v[242:243], s[34:35] op_sel_hi:[1,0]
    v_pk_mul_f32 v[244:245], v[244:245], s[34:35] op_sel_hi:[1,0]
    v_pk_mul_f32 v[246:247], v[246:247], s[34:35] op_sel_hi:[1,0]
    v_cvt_pk_bf16_f32 v236, v240, v241
    v_cvt_pk_bf16_f32 v237, v242, v243
    v_cvt_pk_bf16_f32 v238, v244, v245
    v_cvt_pk_bf16_f32 v239, v246, v247
    v_add_u32 v23, 16384, v14
    s_nop 1
    v_mfma_f32_16x16x32_bf16 v[240:243], a[192:195], v[224:227], 0
    s_add_u32 m0, s54, 0
    v_accvgpr_write_b32 a112, v224
    v_mfma_f32_16x16x32_bf16 v[240:243], a[196:199], v[228:231], v[240:243]
    buffer_load_dwordx4 v23, s[16:19], 0 offen offset:0 nt lds
    v_accvgpr_write_b32 a113, v225
    v_mfma_f32_16x16x32_bf16 v[240:243], a[200:203], v[232:235], v[240:243]
    s_add_u32 m0, s54, 64
    v_accvgpr_write_b32 a114, v226
    v_mfma_f32_16x16x32_bf16 v[240:243], a[204:207], v[236:239], v[240:243]
    buffer_load_dwordx4 v23, s[16:19], 0 offen offset:1024 nt lds
    v_accvgpr_write_b32 a115, v227
    v_mfma_f32_16x16x32_bf16 v[244:247], a[208:211], v[224:227], 0
    s_add_u32 m0, s54, 128
    v_accvgpr_write_b32 a116, v228
    v_mfma_f32_16x16x32_bf16 v[244:247], a[212:215], v[228:231], v[244:247]
    buffer_load_dwordx4 v23, s[16:19], 0 offen offset:2048 nt lds
    v_accvgpr_write_b32 a117, v229
    v_mfma_f32_16x16x32_bf16 v[244:247], a[216:219], v[232:235], v[244:247]
    s_add_u32 m0, s54, 192
    v_accvgpr_write_b32 a118, v230
    v_mfma_f32_16x16x32_bf16 v[244:247], a[220:223], v[236:239], v[244:247]
    buffer_load_dwordx4 v23, s[16:19], 0 offen offset:3072 nt lds
    v_accvgpr_write_b32 a119, v231
    v_mfma_f32_16x16x32_bf16 v[136:139], a[224:227], v[224:227], 0
    v_accvgpr_write_b32 a120, v232
    v_mfma_f32_16x16x32_bf16 v[136:139], a[228:231], v[228:231], v[136:139]
    v_accvgpr_write_b32 a121, v233
    v_mfma_f32_16x16x32_bf16 v[136:139], a[232:235], v[232:235], v[136:139]
    v_accvgpr_write_b32 a122, v234
    v_mfma_f32_16x16x32_bf16 v[136:139], a[236:239], v[236:239], v[136:139]
    v_accvgpr_write_b32 a123, v235
    v_max3_f32 v20, v240, v240, v241
    v_mfma_f32_16x16x32_bf16 v[140:143], a[240:243], v[224:227], 0
    v_accvgpr_write_b32 a124, v236
    v_max3_f32 v20, v20, v242, v243
    v_mfma_f32_16x16x32_bf16 v[140:143], a[244:247], v[228:231], v[140:143]
    v_accvgpr_write_b32 a125, v237
    v_max3_f32 v20, v20, v244, v245
    v_mfma_f32_16x16x32_bf16 v[140:143], a[248:251], v[232:235], v[140:143]
    v_accvgpr_write_b32 a126, v238
    v_max3_f32 v20, v20, v246, v247
    v_mfma_f32_16x16x32_bf16 v[140:143], a[252:255], v[236:239], v[140:143]
    v_accvgpr_write_b32 a127, v239
    s_cmp_lg_u32 s3, 0
    s_cbranch_scc1 L_skipmax1
    v_max3_f32 v20, v20, v136, v137
    v_max3_f32 v20, v20, v138, v139
    s_nop 3
    v_max3_f32 v20, v20, v140, v141
    v_max3_f32 v20, v20, v142, v143
    v_mov_b32 v21, v20
    s_nop 1
    v_permlane16_swap_b32 v20, v21
    v_max_f32 v20, v20, v21
    v_mov_b32 v21, v20
    s_nop 1
    v_permlane32_swap_b32 v20, v21
    v_max_f32 v20, v20, v21
    v_sub_f32 v204, 0, v20
    v_mov_b32 v205, v204
    v_mov_b32 v206, v204
    v_mov_b32 v207, v204
L_skipmax1:
    v_pk_add_f32 v[240:241], v[240:241], v[204:205]
    v_pk_add_f32 v[242:243], v[242:243], v[204:205]
    v_pk_add_f32 v[244:245], v[244:245], v[204:205]
    v_pk_add_f32 v[246:247], v[246:247], v[204:205]
    v_pk_add_f32 v[136:137], v[136:137], v[204:205]
    v_pk_add_f32 v[138:139], v[138:139], v[204:205]
    v_pk_add_f32 v[140:141], v[140:141], v[204:205]
    v_pk_add_f32 v[142:143], v[142:143], v[204:205]
    v_exp_f32 v240, v240
    v_exp_f32 v241, v241
    v_exp_f32 v242, v242
    v_exp_f32 v243, v243
    v_exp_f32 v244, v244
    v_exp_f32 v245, v245
    v_exp_f32 v246, v246
    v_exp_f32 v247, v247
    v_exp_f32 v136, v136
    v_exp_f32 v137, v137
    v_exp_f32 v138, v138
    v_exp_f32 v139, v139
    v_exp_f32 v140, v140
    v_exp_f32 v141, v141
    v_exp_f32 v142, v142
    v_exp_f32 v143, v143
    s_waitcnt vmcnt(8)
    v_add_u32 v20, s53, v4
    ds_read_b128 v[224:227], v20 offset:0
    ds_read_b128 v[228:231], v20 offset:64
    ds_read_b128 v[232:235], v20 offset:128
    ds_read_b128 v[236:239], v20 offset:192
    v_cvt_pk_bf16_f32 v100, v240, v241
    v_cvt_pk_bf16_f32 v101, v242, v243
    v_cvt_pk_bf16_f32 v102, v244, v245
    v_cvt_pk_bf16_f32 v103, v246, v247
    v_add_f32 v9, v240, v241
    v_add_f32 v9, v9, v242
    v_add_f32 v9, v9, v243
    v_add_f32 v9, v9, v244
    v_add_f32 v9, v9, v245
    v_add_f32 v9, v9, v246
    v_add_f32 v9, v9, v247
    v_cvt_pk_bf16_f32 v180, v136, v137
    v_cvt_pk_bf16_f32 v181, v138, v139
    v_cvt_pk_bf16_f32 v182, v140, v141
    v_cvt_pk_bf16_f32 v183, v142, v143
    v_add_f32 v9, v9, v136
    v_add_f32 v9, v9, v137
    v_add_f32 v9, v9, v138
    v_add_f32 v9, v9, v139
    v_add_f32 v9, v9, v140
    v_add_f32 v9, v9, v141
    v_add_f32 v9, v9, v142
    v_add_f32 v9, v9, v143
    s_waitcnt lgkmcnt(3)
    v_lshlrev_b32 v240, 16, v224
    v_and_b32 v241, 0xffff0000, v224
    v_lshlrev_b32 v242, 16, v225
    v_and_b32 v243, 0xffff0000, v225
    v_lshlrev_b32 v244, 16, v226
    v_and_b32 v245, 0xffff0000, v226
    v_lshlrev_b32 v246, 16, v227
    v_and_b32 v247, 0xffff0000, v227
    v_pk_mul_f32 v[240:241], v[240:241], s[34:35] op_sel_hi:[1,0]
    v_pk_mul_f32 v[242:243], v[242:243], s[34:35] op_sel_hi:[1,0]
    v_pk_mul_f32 v[244:245], v[244:245], s[34:35] op_sel_hi:[1,0]
    v_pk_mul_f32 v[246:247], v[246:247], s[34:35] op_sel_hi:[1,0]
    v_cvt_pk_bf16_f32 v224, v240, v241
    v_cvt_pk_bf16_f32 v225, v242, v243
    v_cvt_pk_bf16_f32 v226, v244, v245
    v_cvt_pk_bf16_f32 v227, v246, v247
    s_waitcnt lgkmcnt(2)
    v_lshlrev_b32 v240, 16, v228
    v_and_b32 v241, 0xffff0000, v228
    v_lshlrev_b32 v242, 16, v229
    v_and_b32 v243, 0xffff0000, v229
    v_lshlrev_b32 v244, 16, v230
    v_and_b32 v245, 0xffff0000, v230
    v_lshlrev_b32 v246, 16, v231
    v_and_b32 v247, 0xffff0000, v231
    v_pk_mul_f32 v[240:241], v[240:241], s[34:35] op_sel_hi:[1,0]
    v_pk_mul_f32 v[242:243], v[242:243], s[34:35] op_sel_hi:[1,0]
    v_pk_mul_f32 v[244:245], v[244:245], s[34:35] op_sel_hi:[1,0]
    v_pk_mul_f32 v[246:247], v[246:247], s[34:35] op_sel_hi:[1,0]
    v_cvt_pk_bf16_f32 v228, v240, v241
    v_cvt_pk_bf16_f32 v229, v242, v243
    v_cvt_pk_bf16_f32 v230, v244, v245
    v_cvt_pk_bf16_f32 v231, v246, v247
    s_waitcnt lgkmcnt(1)
    v_lshlrev_b32 v240, 16, v232
    v_and_b32 v241, 0xffff0000, v232
    v_lshlrev_b32 v242, 16, v233
    v_and_b32 v243, 0xffff0000, v233
    v_lshlrev_b32 v244, 16, v234
    v_and_b32 v245, 0xffff0000, v234
    v_lshlrev_b32 v246, 16, v235
    v_and_b32 v247, 0xffff0000, v235
    v_pk_mul_f32 v[240:241], v[240:241], s[34:35] op_sel_hi:[1,0]
    v_pk_mul_f32 v[242:243], v[242:243], s[34:35] op_sel_hi:[1,0]
    v_pk_mul_f32 v[244:245], v[244:245], s[34:35] op_sel_hi:[1,0]
    v_pk_mul_f32 v[246:247], v[246:247], s[34:35] op_sel_hi:[1,0]
    v_cvt_pk_bf16_f32 v232, v240, v241
    v_cvt_pk_bf16_f32 v233, v242, v243
    v_cvt_pk_bf16_f32 v234, v244, v245
    v_cvt_pk_bf16_f32 v235, v246, v247
    s_waitcnt lgkmcnt(0)
    v_lshlrev_b32 v240, 16, v236
    v_and_b32 v241, 0xffff0000, v236
    v_lshlrev_b32 v242, 16, v237
    v_and_b32 v243, 0xffff0000, v237
    v_lshlrev_b32 v244, 16, v238
    v_and_b32 v245, 0xffff0000, v238
    v_lshlrev_b32 v246, 16, v239
    v_and_b32 v247, 0xffff0000, v239
    v_pk_mul_f32 v[240:241], v[240:241], s[34:35] op_sel_hi:[1,0]
    v_pk_mul_f32 v[242:243], v[242:243], s[34:35] op_sel_hi:[1,0]
    v_pk_mul_f32 v[244:245], v[244:245], s[34:35] op_sel_hi:[1,0]
    v_pk_mul_f32 v[246:247], v[246:247], s[34:35] op_sel_hi:[1,0]
    v_cvt_pk_bf16_f32 v236, v240, v241
    v_cvt_pk_bf16_f32 v237, v242, v243
    v_cvt_pk_bf16_f32 v238, v244, v245
    v_cvt_pk_bf16_f32 v239, v246, v247
    v_add_u32 v23, 20480, v14
    s_nop 1
    v_mfma_f32_16x16x32_bf16 v[240:243], a[192:195], v[224:227], 0
    s_add_u32 m0, s54, 4352
    v_accvgpr_write_b32 a128, v224
    v_mfma_f32_16x16x32_bf16 v[240:243], a[196:199], v[228:231], v[240:243]
    buffer_load_dwordx4 v23, s[16:19], 0 offen offset:0 nt lds
    v_accvgpr_write_b32 a129, v225
    v_mfma_f32_16x16x32_bf16 v[240:243], a[200:203], v[232:235], v[240:243]
    s_add_u32 m0, s54, 4416
    v_accvgpr_write_b32 a130, v226
    v_mfma_f32_16x16x32_bf16 v[240:243], a[204:207], v[236:239], v[240:243]
    buffer_load_dwordx4 v23, s[16:19], 0 offen offset:1024 nt lds
    v_accvgpr_write_b32 a131, v227
    v_mfma_f32_16x16x32_bf16 v[244:247], a[208:211], v[224:227], 0
    s_add_u32 m0, s54, 4480
    v_accvgpr_write_b32 a132, v228
    v_mfma_f32_16x16x32_bf16 v[244:247], a[212:215], v[228:231], v[244:247]
    buffer_load_dwordx4 v23, s[16:19], 0 offen offset:2048 nt lds
    v_accvgpr_write_b32 a133, v229
    v_mfma_f32_16x16x32_bf16 v[244:247], a[216:219], v[232:235], v[244:247]
    s_add_u32 m0, s54, 4544
    v_accvgpr_write_b32 a134, v230
    v_mfma_f32_16x16x32_bf16 v[244:247], a[220:223], v[236:239], v[244:247]
    buffer_load_dwordx4 v23, s[16:19], 0 offen offset:3072 nt lds
    v_accvgpr_write_b32 a135, v231
    v_mfma_f32_16x16x32_bf16 v[144:147], a[224:227], v[224:227], 0
    v_accvgpr_write_b32 a136, v232
    v_mfma_f32_16x16x32_bf16 v[144:147], a[228:231], v[228:231], v[144:147]
    v_accvgpr_write_b32 a137, v233
    v_mfma_f32_16x16x32_bf16 v[144:147], a[232:235], v[232:235], v[144:147]
    v_accvgpr_write_b32 a138, v234
    v_mfma_f32_16x16x32_bf16 v[144:147], a[236:239], v[236:239], v[144:147]
    v_accvgpr_write_b32 a139, v235
    v_max3_f32 v20, v240, v240, v241
    v_mfma_f32_16x16x32_bf16 v[148:151], a[240:243], v[224:227], 0
    v_accvgpr_write_b32 a140, v236
    v_max3_f32 v20, v20, v242, v243
    v_mfma_f32_16x16x32_bf16 v[148:151], a[244:247], v[228:231], v[148:151]
    v_accvgpr_write_b32 a141, v237
    v_max3_f32 v20, v20, v244, v245
    v_mfma_f32_16x16x32_bf16 v[148:151], a[248:251], v[232:235], v[148:151]
    v_accvgpr_write_b32 a142, v238
    v_max3_f32 v20, v20, v246, v247
    v_mfma_f32_16x16x32_bf16 v[148:151], a[252:255], v[236:239], v[148:151]
    v_accvgpr_write_b32 a143, v239
    s_cmp_lg_u32 s3, 0
    s_cbranch_scc1 L_skipmax2
    v_max3_f32 v20, v20, v144, v145
    v_max3_f32 v20, v20, v146, v147
    s_nop 3
    v_max3_f32 v20, v20, v148, v149
    v_max3_f32 v20, v20, v150, v151
    v_mov_b32 v21, v20
    s_nop 1
    v_permlane16_swap_b32 v20, v21
    v_max_f32 v20, v20, v21
    v_mov_b32 v21, v20
    s_nop 1
    v_permlane32_swap_b32 v20, v21
    v_max_f32 v20, v20, v21
    v_sub_f32 v208, 0, v20
    v_mov_b32 v209, v208
    v_mov_b32 v210, v208
    v_mov_b32 v211, v208
L_skipmax2:
    v_pk_add_f32 v[240:241], v[240:241], v[208:209]
    v_pk_add_f32 v[242:243], v[242:243], v[208:209]
    v_pk_add_f32 v[244:245], v[244:245], v[208:209]
    v_pk_add_f32 v[246:247], v[246:247], v[208:209]
    v_pk_add_f32 v[144:145], v[144:145], v[208:209]
    v_pk_add_f32 v[146:147], v[146:147], v[208:209]
    v_pk_add_f32 v[148:149], v[148:149], v[208:209]
    v_pk_add_f32 v[150:151], v[150:151], v[208:209]
    v_exp_f32 v240, v240
    v_exp_f32 v241, v241
    v_exp_f32 v242, v242
    v_exp_f32 v243, v243
    v_exp_f32 v244, v244
    v_exp_f32 v245, v245
    v_exp_f32 v246, v246
    v_exp_f32 v247, v247
    v_exp_f32 v144, v144
    v_exp_f32 v145, v145
    v_exp_f32 v146, v146
    v_exp_f32 v147, v147
    v_exp_f32 v148, v148
    v_exp_f32 v149, v149
    v_exp_f32 v150, v150
    v_exp_f32 v151, v151
    s_waitcnt vmcnt(8)
    v_add_u32 v20, s53, v4
    ds_read_b128 v[224:227], v20 offset:4352
    ds_read_b128 v[228:231], v20 offset:4416
    ds_read_b128 v[232:235], v20 offset:4480
    ds_read_b128 v[236:239], v20 offset:4544
    v_cvt_pk_bf16_f32 v104, v240, v241
    v_cvt_pk_bf16_f32 v105, v242, v243
    v_cvt_pk_bf16_f32 v106, v244, v245
    v_cvt_pk_bf16_f32 v107, v246, v247
    v_add_f32 v10, v240, v241
    v_add_f32 v10, v10, v242
    v_add_f32 v10, v10, v243
    v_add_f32 v10, v10, v244
    v_add_f32 v10, v10, v245
    v_add_f32 v10, v10, v246
    v_add_f32 v10, v10, v247
    v_cvt_pk_bf16_f32 v184, v144, v145
    v_cvt_pk_bf16_f32 v185, v146, v147
    v_add_f32 v10, v10, v144
    v_cvt_pk_bf16_f32 v186, v148, v149
    v_add_f32 v10, v10, v145
    v_cvt_pk_bf16_f32 v187, v150, v151
    v_add_f32 v10, v10, v146
    v_add_f32 v10, v10, v147
    v_add_f32 v10, v10, v148
    v_add_f32 v10, v10, v149
    v_add_f32 v10, v10, v150
    v_add_f32 v10, v10, v151
    s_waitcnt lgkmcnt(3)
    v_lshlrev_b32 v240, 16, v224
    v_and_b32 v241, 0xffff0000, v224
    v_lshlrev_b32 v242, 16, v225
    v_and_b32 v243, 0xffff0000, v225
    v_lshlrev_b32 v244, 16, v226
    v_and_b32 v245, 0xffff0000, v226
    v_lshlrev_b32 v246, 16, v227
    v_and_b32 v247, 0xffff0000, v227
    v_pk_mul_f32 v[240:241], v[240:241], s[34:35] op_sel_hi:[1,0]
    v_pk_mul_f32 v[242:243], v[242:243], s[34:35] op_sel_hi:[1,0]
    v_pk_mul_f32 v[244:245], v[244:245], s[34:35] op_sel_hi:[1,0]
    v_pk_mul_f32 v[246:247], v[246:247], s[34:35] op_sel_hi:[1,0]
    v_cvt_pk_bf16_f32 v224, v240, v241
    v_cvt_pk_bf16_f32 v225, v242, v243
    v_cvt_pk_bf16_f32 v226, v244, v245
    v_cvt_pk_bf16_f32 v227, v246, v247
    s_waitcnt lgkmcnt(2)
    v_lshlrev_b32 v240, 16, v228
    v_and_b32 v241, 0xffff0000, v228
    v_lshlrev_b32 v242, 16, v229
    v_and_b32 v243, 0xffff0000, v229
    v_lshlrev_b32 v244, 16, v230
    v_and_b32 v245, 0xffff0000, v230
    v_lshlrev_b32 v246, 16, v231
    v_and_b32 v247, 0xffff0000, v231
    v_pk_mul_f32 v[240:241], v[240:241], s[34:35] op_sel_hi:[1,0]
    v_pk_mul_f32 v[242:243], v[242:243], s[34:35] op_sel_hi:[1,0]
    v_pk_mul_f32 v[244:245], v[244:245], s[34:35] op_sel_hi:[1,0]
    v_pk_mul_f32 v[246:247], v[246:247], s[34:35] op_sel_hi:[1,0]
    v_cvt_pk_bf16_f32 v228, v240, v241
    v_cvt_pk_bf16_f32 v229, v242, v243
    v_cvt_pk_bf16_f32 v230, v244, v245
    v_cvt_pk_bf16_f32 v231, v246, v247
    s_waitcnt lgkmcnt(1)
    v_lshlrev_b32 v240, 16, v232
    v_and_b32 v241, 0xffff0000, v232
    v_lshlrev_b32 v242, 16, v233
    v_and_b32 v243, 0xffff0000, v233
    v_lshlrev_b32 v244, 16, v234
    v_and_b32 v245, 0xffff0000, v234
    v_lshlrev_b32 v246, 16, v235
    v_and_b32 v247, 0xffff0000, v235
    v_pk_mul_f32 v[240:241], v[240:241], s[34:35] op_sel_hi:[1,0]
    v_pk_mul_f32 v[242:243], v[242:243], s[34:35] op_sel_hi:[1,0]
    v_pk_mul_f32 v[244:245], v[244:245], s[34:35] op_sel_hi:[1,0]
    v_pk_mul_f32 v[246:247], v[246:247], s[34:35] op_sel_hi:[1,0]
    v_cvt_pk_bf16_f32 v232, v240, v241
    v_cvt_pk_bf16_f32 v233, v242, v243
    v_cvt_pk_bf16_f32 v234, v244, v245
    v_cvt_pk_bf16_f32 v235, v246, v247
    s_waitcnt lgkmcnt(0)
    v_lshlrev_b32 v240, 16, v236
    v_and_b32 v241, 0xffff0000, v236
    v_lshlrev_b32 v242, 16, v237
    v_and_b32 v243, 0xffff0000, v237
    v_lshlrev_b32 v244, 16, v238
    v_and_b32 v245, 0xffff0000, v238
    v_lshlrev_b32 v246, 16, v239
    v_and_b32 v247, 0xffff0000, v239
    v_pk_mul_f32 v[240:241], v[240:241], s[34:35] op_sel_hi:[1,0]
    v_pk_mul_f32 v[242:243], v[242:243], s[34:35] op_sel_hi:[1,0]
    v_pk_mul_f32 v[244:245], v[244:245], s[34:35] op_sel_hi:[1,0]
    v_pk_mul_f32 v[246:247], v[246:247], s[34:35] op_sel_hi:[1,0]
    v_cvt_pk_bf16_f32 v236, v240, v241
    v_cvt_pk_bf16_f32 v237, v242, v243
    v_cvt_pk_bf16_f32 v238, v244, v245
    v_cvt_pk_bf16_f32 v239, v246, v247
    s_nop 1
    v_mfma_f32_16x16x32_bf16 v[240:243], a[192:195], v[224:227], 0
    s_add_u32 m0, s43, 0
    v_accvgpr_write_b32 a144, v224
    v_mfma_f32_16x16x32_bf16 v[240:243], a[196:199], v[228:231], v[240:243]
    s_mov_b32 s47, 0
    v_accvgpr_write_b32 a145, v225
    v_mfma_f32_16x16x32_bf16 v[240:243], a[200:203], v[232:235], v[240:243]
    buffer_load_dwordx4 v3, s[24:27], s47 offen offset:0 nt lds
    v_accvgpr_write_b32 a146, v226
    v_mfma_f32_16x16x32_bf16 v[240:243], a[204:207], v[236:239], v[240:243]
    s_add_u32 m0, s43, 800
    v_accvgpr_write_b32 a147, v227
    v_mfma_f32_16x16x32_bf16 v[244:247], a[208:211], v[224:227], 0
    buffer_load_dwordx4 v3, s[24:27], s47 offen offset:256 nt lds
    v_accvgpr_write_b32 a148, v228
    v_mfma_f32_16x16x32_bf16 v[244:247], a[212:215], v[228:231], v[244:247]
    s_add_u32 m0, s43, 8448
    v_accvgpr_write_b32 a149, v229
    v_mfma_f32_16x16x32_bf16 v[244:247], a[216:219], v[232:235], v[244:247]
    s_mov_b32 s47, 8192
    v_accvgpr_write_b32 a150, v230
    v_mfma_f32_16x16x32_bf16 v[244:247], a[220:223], v[236:239], v[244:247]
    buffer_load_dwordx4 v3, s[24:27], s47 offen offset:0 nt lds
    v_accvgpr_write_b32 a151, v231
    v_mfma_f32_16x16x32_bf16 v[152:155], a[224:227], v[224:227], 0
    s_add_u32 m0, s43, 9248
    v_accvgpr_write_b32 a152, v232
    v_mfma_f32_16x16x32_bf16 v[152:155], a[228:231], v[228:231], v[152:155]
    buffer_load_dwordx4 v3, s[24:27], s47 offen offset:256 nt lds
    v_accvgpr_write_b32 a153, v233
    v_mfma_f32_16x16x32_bf16 v[152:155], a[232:235], v[232:235], v[152:155]
    v_accvgpr_write_b32 a154, v234
    v_mfma_f32_16x16x32_bf16 v[152:155], a[236:239], v[236:239], v[152:155]
    v_accvgpr_write_b32 a155, v235
    v_max3_f32 v20, v240, v240, v241
    v_mfma_f32_16x16x32_bf16 v[156:159], a[240:243], v[224:227], 0
    v_accvgpr_write_b32 a156, v236
    v_max3_f32 v20, v20, v242, v243
    v_mfma_f32_16x16x32_bf16 v[156:159], a[244:247], v[228:231], v[156:159]
    v_accvgpr_write_b32 a157, v237
    v_max3_f32 v20, v20, v244, v245
    v_mfma_f32_16x16x32_bf16 v[156:159], a[248:251], v[232:235], v[156:159]
    v_accvgpr_write_b32 a158, v238
    v_max3_f32 v20, v20, v246, v247
    v_mfma_f32_16x16x32_bf16 v[156:159], a[252:255], v[236:239], v[156:159]
    v_accvgpr_write_b32 a159, v239
    s_cmp_lg_u32 s3, 0
    s_cbranch_scc1 L_skipmax3
    v_max3_f32 v20, v20, v152, v153
    v_max3_f32 v20, v20, v154, v155
    s_nop 3
    v_max3_f32 v20, v20, v156, v157
    v_max3_f32 v20, v20, v158, v159
    v_mov_b32 v21, v20
    s_nop 1
    v_permlane16_swap_b32 v20, v21
    v_max_f32 v20, v20, v21
    v_mov_b32 v21, v20
    s_nop 1
    v_permlane32_swap_b32 v20, v21
    v_max_f32 v20, v20, v21
    v_sub_f32 v212, 0, v20
    v_mov_b32 v213, v212
    v_mov_b32 v214, v212
    v_mov_b32 v215, v212
L_skipmax3:
    v_pk_add_f32 v[240:241], v[240:241], v[212:213]
    v_pk_add_f32 v[242:243], v[242:243], v[212:213]
    v_pk_add_f32 v[244:245], v[244:245], v[212:213]
    v_pk_add_f32 v[246:247], v[246:247], v[212:213]
    v_pk_add_f32 v[152:153], v[152:153], v[212:213]
    v_pk_add_f32 v[154:155], v[154:155], v[212:213]
    v_pk_add_f32 v[156:157], v[156:157], v[212:213]
    v_pk_add_f32 v[158:159], v[158:159], v[212:213]
    v_exp_f32 v240, v240
    v_exp_f32 v241, v241
    v_exp_f32 v242, v242
    v_exp_f32 v243, v243
    v_exp_f32 v244, v244
    v_exp_f32 v245, v245
    v_exp_f32 v246, v246
    v_exp_f32 v247, v247
    s_waitcnt vmcnt(8)
    v_add_u32 v20, s54, v4
    ds_read_b128 v[224:227], v20 offset:0
    ds_read_b128 v[228:231], v20 offset:64
    ds_read_b128 v[232:235], v20 offset:128
    ds_read_b128 v[236:239], v20 offset:192
    v_cvt_pk_bf16_f32 v108, v240, v241
    v_cvt_pk_bf16_f32 v109, v242, v243
    v_cvt_pk_bf16_f32 v110, v244, v245
    v_cvt_pk_bf16_f32 v111, v246, v247
    v_add_f32 v11, v240, v241
    v_add_f32 v11, v11, v242
    v_add_f32 v11, v11, v243
    v_add_f32 v11, v11, v244
    v_add_f32 v11, v11, v245
    v_add_f32 v11, v11, v246
    v_add_f32 v11, v11, v247
    s_waitcnt lgkmcnt(3)
    v_lshlrev_b32 v240, 16, v224
    v_and_b32 v241, 0xffff0000, v224
    v_lshlrev_b32 v242, 16, v225
    v_and_b32 v243, 0xffff0000, v225
    v_lshlrev_b32 v244, 16, v226
    v_and_b32 v245, 0xffff0000, v226
    v_lshlrev_b32 v246, 16, v227
    v_and_b32 v247, 0xffff0000, v227
    v_pk_mul_f32 v[240:241], v[240:241], s[34:35] op_sel_hi:[1,0]
    v_pk_mul_f32 v[242:243], v[242:243], s[34:35] op_sel_hi:[1,0]
    v_pk_mul_f32 v[244:245], v[244:245], s[34:35] op_sel_hi:[1,0]
    v_pk_mul_f32 v[246:247], v[246:247], s[34:35] op_sel_hi:[1,0]
    v_cvt_pk_bf16_f32 v224, v240, v241
    v_cvt_pk_bf16_f32 v225, v242, v243
    v_cvt_pk_bf16_f32 v226, v244, v245
    v_cvt_pk_bf16_f32 v227, v246, v247
    s_waitcnt lgkmcnt(2)
    v_lshlrev_b32 v240, 16, v228
    v_and_b32 v241, 0xffff0000, v228
    v_lshlrev_b32 v242, 16, v229
    v_and_b32 v243, 0xffff0000, v229
    v_lshlrev_b32 v244, 16, v230
    v_and_b32 v245, 0xffff0000, v230
    v_lshlrev_b32 v246, 16, v231
    v_and_b32 v247, 0xffff0000, v231
    v_pk_mul_f32 v[240:241], v[240:241], s[34:35] op_sel_hi:[1,0]
    v_pk_mul_f32 v[242:243], v[242:243], s[34:35] op_sel_hi:[1,0]
    v_pk_mul_f32 v[244:245], v[244:245], s[34:35] op_sel_hi:[1,0]
    v_pk_mul_f32 v[246:247], v[246:247], s[34:35] op_sel_hi:[1,0]
    v_cvt_pk_bf16_f32 v228, v240, v241
    v_cvt_pk_bf16_f32 v229, v242, v243
    v_cvt_pk_bf16_f32 v230, v244, v245
    v_cvt_pk_bf16_f32 v231, v246, v247
    s_waitcnt lgkmcnt(1)
    v_lshlrev_b32 v240, 16, v232
    v_and_b32 v241, 0xffff0000, v232
    v_lshlrev_b32 v242, 16, v233
    v_and_b32 v243, 0xffff0000, v233
    v_lshlrev_b32 v244, 16, v234
    v_and_b32 v245, 0xffff0000, v234
    v_lshlrev_b32 v246, 16, v235
    v_and_b32 v247, 0xffff0000, v235
    v_pk_mul_f32 v[240:241], v[240:241], s[34:35] op_sel_hi:[1,0]
    v_pk_mul_f32 v[242:243], v[242:243], s[34:35] op_sel_hi:[1,0]
    v_pk_mul_f32 v[244:245], v[244:245], s[34:35] op_sel_hi:[1,0]
    v_pk_mul_f32 v[246:247], v[246:247], s[34:35] op_sel_hi:[1,0]
    v_cvt_pk_bf16_f32 v232, v240, v241
    v_cvt_pk_bf16_f32 v233, v242, v243
    v_cvt_pk_bf16_f32 v234, v244, v245
    v_cvt_pk_bf16_f32 v235, v246, v247
    s_waitcnt lgkmcnt(0)
    v_lshlrev_b32 v240, 16, v236
    v_and_b32 v241, 0xffff0000, v236
    v_lshlrev_b32 v242, 16, v237
    v_and_b32 v243, 0xffff0000, v237
    v_lshlrev_b32 v244, 16, v238
    v_and_b32 v245, 0xffff0000, v238
    v_lshlrev_b32 v246, 16, v239
    v_and_b32 v247, 0xffff0000, v239
    v_pk_mul_f32 v[240:241], v[240:241], s[34:35] op_sel_hi:[1,0]
    v_pk_mul_f32 v[242:243], v[242:243], s[34:35] op_sel_hi:[1,0]
    v_pk_mul_f32 v[244:245], v[244:245], s[34:35] op_sel_hi:[1,0]
    v_pk_mul_f32 v[246:247], v[246:247], s[34:35] op_sel_hi:[1,0]
    v_cvt_pk_bf16_f32 v236, v240, v241
    v_cvt_pk_bf16_f32 v237, v242, v243
    v_cvt_pk_bf16_f32 v238, v244, v245
    v_cvt_pk_bf16_f32 v239, v246, v247
    s_nop 1
    v_mfma_f32_16x16x32_bf16 v[240:243], a[192:195], v[224:227], 0
    s_add_u32 m0, s42, 17408
    v_accvgpr_write_b32 a160, v224
    v_mfma_f32_16x16x32_bf16 v[240:243], a[196:199], v[228:231], v[240:243]
    s_mov_b32 s47, 16384
    v_accvgpr_write_b32 a161, v225
    v_mfma_f32_16x16x32_bf16 v[240:243], a[200:203], v[232:235], v[240:243]
    buffer_load_dwordx4 v2, s[20:23], s47 offen offset:0 nt lds
    v_accvgpr_write_b32 a162, v226
    v_mfma_f32_16x16x32_bf16 v[240:243], a[204:207], v[236:239], v[240:243]
    s_add_u32 m0, s42, 17472
    v_accvgpr_write_b32 a163, v227
    v_mfma_f32_16x16x32_bf16 v[244:247], a[208:211], v[224:227], 0
    buffer_load_dwordx4 v2, s[20:23], s47 offen offset:1024 nt lds
    v_accvgpr_write_b32 a164, v228
    v_mfma_f32_16x16x32_bf16 v[244:247], a[212:215], v[228:231], v[244:247]
    v_accvgpr_write_b32 a165, v229
    v_mfma_f32_16x16x32_bf16 v[244:247], a[216:219], v[232:235], v[244:247]
    v_accvgpr_write_b32 a166, v230
    v_mfma_f32_16x16x32_bf16 v[244:247], a[220:223], v[236:239], v[244:247]
    v_accvgpr_write_b32 a167, v231
    v_mfma_f32_16x16x32_bf16 v[160:163], a[224:227], v[224:227], 0
    v_accvgpr_write_b32 a168, v232
    v_mfma_f32_16x16x32_bf16 v[160:163], a[228:231], v[228:231], v[160:163]
    v_accvgpr_write_b32 a169, v233
    v_mfma_f32_16x16x32_bf16 v[160:163], a[232:235], v[232:235], v[160:163]
    v_accvgpr_write_b32 a170, v234
    v_mfma_f32_16x16x32_bf16 v[160:163], a[236:239], v[236:239], v[160:163]
    v_accvgpr_write_b32 a171, v235
    v_max3_f32 v20, v240, v240, v241
    v_mfma_f32_16x16x32_bf16 v[164:167], a[240:243], v[224:227], 0
    v_accvgpr_write_b32 a172, v236
    v_max3_f32 v20, v20, v242, v243
    v_mfma_f32_16x16x32_bf16 v[164:167], a[244:247], v[228:231], v[164:167]
    v_accvgpr_write_b32 a173, v237
    v_max3_f32 v20, v20, v244, v245
    v_mfma_f32_16x16x32_bf16 v[164:167], a[248:251], v[232:235], v[164:167]
    v_accvgpr_write_b32 a174, v238
    v_max3_f32 v20, v20, v246, v247
    v_mfma_f32_16x16x32_bf16 v[164:167], a[252:255], v[236:239], v[164:167]
    v_accvgpr_write_b32 a175, v239
    s_cmp_lg_u32 s3, 0
    s_cbranch_scc1 L_skipmax4
    v_max3_f32 v20, v20, v160, v161
    v_max3_f32 v20, v20, v162, v163
    s_nop 3
    v_max3_f32 v20, v20, v164, v165
    v_max3_f32 v20, v20, v166, v167
    v_mov_b32 v21, v20
    s_nop 1
    v_permlane16_swap_b32 v20, v21
    v_max_f32 v20, v20, v21
    v_mov_b32 v21, v20
    s_nop 1
    v_permlane32_swap_b32 v20, v21
    v_max_f32 v20, v20, v21
    v_sub_f32 v216, 0, v20
    v_mov_b32 v217, v216
    v_mov_b32 v218, v216
    v_mov_b32 v219, v216
L_skipmax4:
    v_pk_add_f32 v[240:241], v[240:241], v[216:217]
    v_pk_add_f32 v[242:243], v[242:243], v[216:217]
    v_pk_add_f32 v[244:245], v[244:245], v[216:217]
    v_pk_add_f32 v[246:247], v[246:247], v[216:217]
    v_pk_add_f32 v[160:161], v[160:161], v[216:217]
    v_pk_add_f32 v[162:163], v[162:163], v[216:217]
    v_pk_add_f32 v[164:165], v[164:165], v[216:217]
    v_pk_add_f32 v[166:167], v[166:167], v[216:217]
    v_exp_f32 v240, v240
    v_exp_f32 v241, v241
    v_exp_f32 v242, v242
    v_exp_f32 v243, v243
    v_exp_f32 v244, v244
    v_exp_f32 v245, v245
    v_exp_f32 v246, v246
    v_exp_f32 v247, v247
    s_waitcnt vmcnt(6)
    v_add_u32 v20, s54, v4
    ds_read_b128 v[224:227], v20 offset:4352
    ds_read_b128 v[228:231], v20 offset:4416
    ds_read_b128 v[232:235], v20 offset:4480
    ds_read_b128 v[236:239], v20 offset:4544
    v_cvt_pk_bf16_f32 v252, v240, v241
    v_cvt_pk_bf16_f32 v253, v242, v243
    v_cvt_pk_bf16_f32 v254, v244, v245
    v_cvt_pk_bf16_f32 v255, v246, v247
    v_add_f32 v12, v240, v241
    v_add_f32 v12, v12, v242
    v_add_f32 v12, v12, v243
    v_add_f32 v12, v12, v244
    v_add_f32 v12, v12, v245
    v_add_f32 v12, v12, v246
    v_add_f32 v12, v12, v247
    s_waitcnt lgkmcnt(3)
    v_lshlrev_b32 v240, 16, v224
    v_and_b32 v241, 0xffff0000, v224
    v_lshlrev_b32 v242, 16, v225
    v_and_b32 v243, 0xffff0000, v225
    v_lshlrev_b32 v244, 16, v226
    v_and_b32 v245, 0xffff0000, v226
    v_lshlrev_b32 v246, 16, v227
    v_and_b32 v247, 0xffff0000, v227
    v_pk_mul_f32 v[240:241], v[240:241], s[34:35] op_sel_hi:[1,0]
    v_pk_mul_f32 v[242:243], v[242:243], s[34:35] op_sel_hi:[1,0]
    v_pk_mul_f32 v[244:245], v[244:245], s[34:35] op_sel_hi:[1,0]
    v_pk_mul_f32 v[246:247], v[246:247], s[34:35] op_sel_hi:[1,0]
    v_cvt_pk_bf16_f32 v224, v240, v241
    v_cvt_pk_bf16_f32 v225, v242, v243
    v_cvt_pk_bf16_f32 v226, v244, v245
    v_cvt_pk_bf16_f32 v227, v246, v247
    s_waitcnt lgkmcnt(2)
    v_lshlrev_b32 v240, 16, v228
    v_and_b32 v241, 0xffff0000, v228
    v_lshlrev_b32 v242, 16, v229
    v_and_b32 v243, 0xffff0000, v229
    v_lshlrev_b32 v244, 16, v230
    v_and_b32 v245, 0xffff0000, v230
    v_lshlrev_b32 v246, 16, v231
    v_and_b32 v247, 0xffff0000, v231
    v_pk_mul_f32 v[240:241], v[240:241], s[34:35] op_sel_hi:[1,0]
    v_pk_mul_f32 v[242:243], v[242:243], s[34:35] op_sel_hi:[1,0]
    v_pk_mul_f32 v[244:245], v[244:245], s[34:35] op_sel_hi:[1,0]
    v_pk_mul_f32 v[246:247], v[246:247], s[34:35] op_sel_hi:[1,0]
    v_cvt_pk_bf16_f32 v228, v240, v241
    v_cvt_pk_bf16_f32 v229, v242, v243
    v_cvt_pk_bf16_f32 v230, v244, v245
    v_cvt_pk_bf16_f32 v231, v246, v247
    s_waitcnt lgkmcnt(1)
    v_lshlrev_b32 v240, 16, v232
    v_and_b32 v241, 0xffff0000, v232
    v_lshlrev_b32 v242, 16, v233
    v_and_b32 v243, 0xffff0000, v233
    v_lshlrev_b32 v244, 16, v234
    v_and_b32 v245, 0xffff0000, v234
    v_lshlrev_b32 v246, 16, v235
    v_and_b32 v247, 0xffff0000, v235
    v_pk_mul_f32 v[240:241], v[240:241], s[34:35] op_sel_hi:[1,0]
    v_pk_mul_f32 v[242:243], v[242:243], s[34:35] op_sel_hi:[1,0]
    v_pk_mul_f32 v[244:245], v[244:245], s[34:35] op_sel_hi:[1,0]
    v_pk_mul_f32 v[246:247], v[246:247], s[34:35] op_sel_hi:[1,0]
    v_cvt_pk_bf16_f32 v232, v240, v241
    v_cvt_pk_bf16_f32 v233, v242, v243
    v_cvt_pk_bf16_f32 v234, v244, v245
    v_cvt_pk_bf16_f32 v235, v246, v247
    s_waitcnt lgkmcnt(0)
    v_lshlrev_b32 v240, 16, v236
    v_and_b32 v241, 0xffff0000, v236
    v_lshlrev_b32 v242, 16, v237
    v_and_b32 v243, 0xffff0000, v237
    v_lshlrev_b32 v244, 16, v238
    v_and_b32 v245, 0xffff0000, v238
    v_lshlrev_b32 v246, 16, v239
    v_and_b32 v247, 0xffff0000, v239
    v_pk_mul_f32 v[240:241], v[240:241], s[34:35] op_sel_hi:[1,0]
    v_pk_mul_f32 v[242:243], v[242:243], s[34:35] op_sel_hi:[1,0]
    v_pk_mul_f32 v[244:245], v[244:245], s[34:35] op_sel_hi:[1,0]
    v_pk_mul_f32 v[246:247], v[246:247], s[34:35] op_sel_hi:[1,0]
    v_cvt_pk_bf16_f32 v236, v240, v241
    v_cvt_pk_bf16_f32 v237, v242, v243
    v_cvt_pk_bf16_f32 v238, v244, v245
    v_cvt_pk_bf16_f32 v239, v246, v247
    s_nop 1
    v_mfma_f32_16x16x32_bf16 v[240:243], a[192:195], v[224:227], 0
    v_accvgpr_write_b32 a176, v224
    v_mfma_f32_16x16x32_bf16 v[240:243], a[196:199], v[228:231], v[240:243]
    v_accvgpr_write_b32 a177, v225
    v_mfma_f32_16x16x32_bf16 v[240:243], a[200:203], v[232:235], v[240:243]
    v_accvgpr_write_b32 a178, v226
    v_mfma_f32_16x16x32_bf16 v[240:243], a[204:207], v[236:239], v[240:243]
    v_accvgpr_write_b32 a179, v227
    v_mfma_f32_16x16x32_bf16 v[244:247], a[208:211], v[224:227], 0
    v_accvgpr_write_b32 a180, v228
    v_mfma_f32_16x16x32_bf16 v[244:247], a[212:215], v[228:231], v[244:247]
    v_accvgpr_write_b32 a181, v229
    v_mfma_f32_16x16x32_bf16 v[244:247], a[216:219], v[232:235], v[244:247]
    v_accvgpr_write_b32 a182, v230
    v_mfma_f32_16x16x32_bf16 v[244:247], a[220:223], v[236:239], v[244:247]
    v_accvgpr_write_b32 a183, v231
    v_mfma_f32_16x16x32_bf16 v[168:171], a[224:227], v[224:227], 0
    v_accvgpr_write_b32 a184, v232
    v_mfma_f32_16x16x32_bf16 v[168:171], a[228:231], v[228:231], v[168:171]
    v_accvgpr_write_b32 a185, v233
    v_mfma_f32_16x16x32_bf16 v[168:171], a[232:235], v[232:235], v[168:171]
    v_accvgpr_write_b32 a186, v234
    v_mfma_f32_16x16x32_bf16 v[168:171], a[236:239], v[236:239], v[168:171]
    v_accvgpr_write_b32 a187, v235
    v_max3_f32 v20, v240, v240, v241
    v_mfma_f32_16x16x32_bf16 v[172:175], a[240:243], v[224:227], 0
    v_accvgpr_write_b32 a188, v236
    v_max3_f32 v20, v20, v242, v243
    v_mfma_f32_16x16x32_bf16 v[172:175], a[244:247], v[228:231], v[172:175]
    v_accvgpr_write_b32 a189, v237
    v_max3_f32 v20, v20, v244, v245
    v_mfma_f32_16x16x32_bf16 v[172:175], a[248:251], v[232:235], v[172:175]
    v_accvgpr_write_b32 a190, v238
    v_max3_f32 v20, v20, v246, v247
    v_mfma_f32_16x16x32_bf16 v[172:175], a[252:255], v[236:239], v[172:175]
    v_accvgpr_write_b32 a191, v239
    s_waitcnt vmcnt(4)
    s_barrier
    ds_read_b64_tr_b16 a[224:225], v5 offset:0
    ds_read_b64_tr_b16 a[226:227], v5 offset:512
    ds_read_b64_tr_b16 a[228:229], v5 offset:32
    ds_read_b64_tr_b16 a[230:231], v5 offset:544
    ds_read_b64_tr_b16 a[232:233], v5 offset:64
    ds_read_b64_tr_b16 a[234:235], v5 offset:576
    ds_read_b64_tr_b16 a[236:237], v5 offset:96
    ds_read_b64_tr_b16 a[238:239], v5 offset:608
    ds_read_b64_tr_b16 a[240:241], v5 offset:128
    ds_read_b64_tr_b16 a[242:243], v5 offset:640
    ds_read_b64_tr_b16 a[244:245], v5 offset:160
    ds_read_b64_tr_b16 a[246:247], v5 offset:672
    ds_read_b64_tr_b16 a[248:249], v5 offset:192
    ds_read_b64_tr_b16 a[250:251], v5 offset:704
    ds_read_b64_tr_b16 a[252:253], v5 offset:224
    ds_read_b64_tr_b16 a[254:255], v5 offset:736
    s_nop 3
    v_max3_f32 v20, v20, v168, v169
    v_max3_f32 v20, v20, v170, v171
    v_max3_f32 v20, v20, v172, v173
    v_max3_f32 v20, v20, v174, v175
    v_mov_b32 v21, v20
    s_nop 1
    v_permlane16_swap_b32 v20, v21
    v_max_f32 v20, v20, v21
    v_mov_b32 v21, v20
    s_nop 1
    v_permlane32_swap_b32 v20, v21
    v_max_f32 v20, v20, v21
    s_waitcnt lgkmcnt(14)
    v_mfma_f32_16x16x32_bf16 a[0:3], a[224:227], v[96:99], 0
    s_add_u32 m0, s43, 16896
    v_sub_f32 v20, s55, v20
    v_cndmask_b32 v220, v20, v220, s[100:101]
    s_waitcnt lgkmcnt(12)
    v_mfma_f32_16x16x32_bf16 a[4:7], a[228:231], v[96:99], 0
    s_mov_b32 s47, 16384
    v_mov_b32 v221, v220
    v_mov_b32 v222, v220
    s_waitcnt lgkmcnt(10)
    v_mfma_f32_16x16x32_bf16 a[8:11], a[232:235], v[96:99], 0
    buffer_load_dwordx4 v3, s[24:27], s47 offen offset:0 nt lds
    s_waitcnt lgkmcnt(8)
    v_mfma_f32_16x16x32_bf16 a[12:15], a[236:239], v[96:99], 0
    s_add_u32 m0, s43, 17696
    v_mov_b32 v223, v220
    v_add_f32 v240, v240, v220
    s_waitcnt lgkmcnt(6)
    v_mfma_f32_16x16x32_bf16 a[16:19], a[240:243], v[96:99], 0
    v_add_f32 v241, v241, v220
    v_add_f32 v242, v242, v220
    s_waitcnt lgkmcnt(4)
    v_mfma_f32_16x16x32_bf16 a[20:23], a[244:247], v[96:99], 0
    buffer_load_dwordx4 v3, s[24:27], s47 offen offset:256 nt lds
    s_waitcnt lgkmcnt(2)
    v_mfma_f32_16x16x32_bf16 a[24:27], a[248:251], v[96:99], 0
    s_add_u32 m0, s42, 26112
    v_add_f32 v243, v243, v220
    v_add_f32 v244, v244, v220
    s_waitcnt lgkmcnt(0)
    v_mfma_f32_16x16x32_bf16 a[28:31], a[252:255], v[96:99], 0
    s_mov_b32 s47, 24576
    v_add_f32 v245, v245, v220
    v_add_f32 v246, v246, v220
    v_mfma_f32_16x16x32_bf16 a[32:35], a[224:227], v[100:103], 0
    buffer_load_dwordx4 v2, s[20:23], s47 offen offset:0 nt lds
    v_mfma_f32_16x16x32_bf16 a[36:39], a[228:231], v[100:103], 0
    s_add_u32 m0, s42, 26176
    v_add_f32 v247, v247, v220
    v_add_f32 v168, v168, v220
    v_mfma_f32_16x16x32_bf16 a[40:43], a[232:235], v[100:103], 0
    v_add_f32 v169, v169, v220
    v_add_f32 v170, v170, v220
    v_mfma_f32_16x16x32_bf16 a[44:47], a[236:239], v[100:103], 0
    buffer_load_dwordx4 v2, s[20:23], s47 offen offset:1024 nt lds
    v_mfma_f32_16x16x32_bf16 a[48:51], a[240:243], v[100:103], 0
    s_mov_b32 s40, 32768
    v_add_f32 v171, v171, v220
    v_add_f32 v172, v172, v220
    v_mfma_f32_16x16x32_bf16 a[52:55], a[244:247], v[100:103], 0
    s_mov_b32 s41, 24576
    v_add_f32 v173, v173, v220
    v_add_f32 v174, v174, v220
    v_mfma_f32_16x16x32_bf16 a[56:59], a[248:251], v[100:103], 0
    s_add_u32 s38, s42, 34816
    v_add_f32 v175, v175, v220
    v_exp_f32 v240, v240
    v_mfma_f32_16x16x32_bf16 a[60:63], a[252:255], v[100:103], 0
    s_add_u32 s39, s43, 25344
    v_exp_f32 v241, v241
    v_mfma_f32_16x16x32_bf16 a[64:67], a[224:227], v[104:107], 0
    s_mov_b32 s36, 17408
    v_exp_f32 v242, v242
    v_mfma_f32_16x16x32_bf16 a[68:71], a[228:231], v[104:107], 0
    s_mov_b32 s37, 8448
    v_exp_f32 v243, v243
    v_mfma_f32_16x16x32_bf16 a[72:75], a[232:235], v[104:107], 0
    s_mov_b32 s35, 2
    v_exp_f32 v244, v244
    v_mfma_f32_16x16x32_bf16 a[76:79], a[236:239], v[104:107], 0
    s_mov_b32 s33, 7606
    v_exp_f32 v245, v245
    v_mfma_f32_16x16x32_bf16 a[80:83], a[240:243], v[104:107], 0
    v_exp_f32 v246, v246
    v_mfma_f32_16x16x32_bf16 a[84:87], a[244:247], v[104:107], 0
    v_exp_f32 v247, v247
    v_mfma_f32_16x16x32_bf16 a[88:91], a[248:251], v[104:107], 0
    v_exp_f32 v168, v168
    v_mfma_f32_16x16x32_bf16 a[92:95], a[252:255], v[104:107], 0
    v_exp_f32 v169, v169
    v_mfma_f32_16x16x32_bf16 v[32:35], a[224:227], v[108:111], 0
    v_cvt_pk_bf16_f32 v248, v240, v241
    v_cvt_pk_bf16_f32 v249, v242, v243
    v_mfma_f32_16x16x32_bf16 v[36:39], a[228:231], v[108:111], 0
    v_cvt_pk_bf16_f32 v250, v244, v245
    v_cvt_pk_bf16_f32 v251, v246, v247
    v_mfma_f32_16x16x32_bf16 v[40:43], a[232:235], v[108:111], 0
    v_add_f32 v13, v240, v241
    v_add_f32 v13, v13, v242
    v_mfma_f32_16x16x32_bf16 v[44:47], a[236:239], v[108:111], 0
    v_add_f32 v13, v13, v243
    v_add_f32 v13, v13, v244
    v_mfma_f32_16x16x32_bf16 v[48:51], a[240:243], v[108:111], 0
    v_add_f32 v13, v13, v245
    v_add_f32 v13, v13, v246
    v_mfma_f32_16x16x32_bf16 v[52:55], a[244:247], v[108:111], 0
    v_add_f32 v13, v13, v247
    v_mov_b64 v[20:21], 0
    v_mfma_f32_16x16x32_bf16 v[56:59], a[248:251], v[108:111], 0
    v_mov_b64 v[22:23], 0
    v_mov_b64 v[24:25], 0
    v_mfma_f32_16x16x32_bf16 v[60:63], a[252:255], v[108:111], 0
    v_mov_b64 v[26:27], 0
    s_waitcnt vmcnt(6)
    s_barrier
    v_mfma_f32_16x16x32_bf16 v[64:67], a[224:227], v[252:255], 0
    v_exp_f32 v152, v152
    v_mfma_f32_16x16x32_bf16 v[96:99], a[224:227], v[248:251], 0
    ds_read_b64_tr_b16 a[224:225], v5 offset:8448
    ds_read_b64_tr_b16 a[226:227], v5 offset:8960
    v_mfma_f32_16x16x32_bf16 v[68:71], a[228:231], v[252:255], 0
    v_exp_f32 v153, v153
    v_mfma_f32_16x16x32_bf16 v[100:103], a[228:231], v[248:251], 0
    ds_read_b64_tr_b16 a[228:229], v5 offset:8480
    ds_read_b64_tr_b16 a[230:231], v5 offset:8992
    v_mfma_f32_16x16x32_bf16 v[72:75], a[232:235], v[252:255], 0
    v_exp_f32 v154, v154
    v_mfma_f32_16x16x32_bf16 v[104:107], a[232:235], v[248:251], 0
    ds_read_b64_tr_b16 a[232:233], v5 offset:8512
    ds_read_b64_tr_b16 a[234:235], v5 offset:9024
    v_mfma_f32_16x16x32_bf16 v[76:79], a[236:239], v[252:255], 0
    v_exp_f32 v155, v155
    v_mfma_f32_16x16x32_bf16 v[108:111], a[236:239], v[248:251], 0
    ds_read_b64_tr_b16 a[236:237], v5 offset:8544
    ds_read_b64_tr_b16 a[238:239], v5 offset:9056
    v_mfma_f32_16x16x32_bf16 v[80:83], a[240:243], v[252:255], 0
    v_exp_f32 v156, v156
    v_mfma_f32_16x16x32_bf16 v[112:115], a[240:243], v[248:251], 0
    ds_read_b64_tr_b16 a[240:241], v5 offset:8576
    ds_read_b64_tr_b16 a[242:243], v5 offset:9088
    v_mfma_f32_16x16x32_bf16 v[84:87], a[244:247], v[252:255], 0
    v_exp_f32 v157, v157
    v_mfma_f32_16x16x32_bf16 v[116:119], a[244:247], v[248:251], 0
    ds_read_b64_tr_b16 a[244:245], v5 offset:8608
    ds_read_b64_tr_b16 a[246:247], v5 offset:9120
    v_mfma_f32_16x16x32_bf16 v[88:91], a[248:251], v[252:255], 0
    v_exp_f32 v158, v158
    v_mfma_f32_16x16x32_bf16 v[120:123], a[248:251], v[248:251], 0
    ds_read_b64_tr_b16 a[248:249], v5 offset:8640
    ds_read_b64_tr_b16 a[250:251], v5 offset:9152
    v_mfma_f32_16x16x32_bf16 v[92:95], a[252:255], v[252:255], 0
    v_exp_f32 v159, v159
    v_mfma_f32_16x16x32_bf16 v[124:127], a[252:255], v[248:251], 0
    ds_read_b64_tr_b16 a[252:253], v5 offset:8672
    ds_read_b64_tr_b16 a[254:255], v5 offset:9184
    s_waitcnt lgkmcnt(14)
    v_mfma_f32_16x16x32_bf16 a[0:3], a[224:227], v[176:179], a[0:3]
    v_cvt_pk_bf16_f32 v188, v152, v153
    v_cvt_pk_bf16_f32 v189, v154, v155
    s_waitcnt lgkmcnt(12)
    v_mfma_f32_16x16x32_bf16 a[4:7], a[228:231], v[176:179], a[4:7]
    v_cvt_pk_bf16_f32 v190, v156, v157
    v_cvt_pk_bf16_f32 v191, v158, v159
    s_waitcnt lgkmcnt(10)
    v_mfma_f32_16x16x32_bf16 a[8:11], a[232:235], v[176:179], a[8:11]
    v_add_f32 v11, v11, v152
    v_add_f32 v11, v11, v153
    s_waitcnt lgkmcnt(8)
    v_mfma_f32_16x16x32_bf16 a[12:15], a[236:239], v[176:179], a[12:15]
    v_add_f32 v11, v11, v154
    v_add_f32 v11, v11, v155
    s_waitcnt lgkmcnt(6)
    v_mfma_f32_16x16x32_bf16 a[16:19], a[240:243], v[176:179], a[16:19]
    v_add_f32 v11, v11, v156
    v_add_f32 v11, v11, v157
    s_waitcnt lgkmcnt(4)
    v_mfma_f32_16x16x32_bf16 a[20:23], a[244:247], v[176:179], a[20:23]
    v_add_f32 v11, v11, v158
    v_add_f32 v11, v11, v159
    s_waitcnt lgkmcnt(2)
    v_mfma_f32_16x16x32_bf16 a[24:27], a[248:251], v[176:179], a[24:27]
    v_exp_f32 v160, v160
    s_waitcnt lgkmcnt(0)
    v_mfma_f32_16x16x32_bf16 a[28:31], a[252:255], v[176:179], a[28:31]
    v_exp_f32 v161, v161
    v_mfma_f32_16x16x32_bf16 a[32:35], a[224:227], v[180:183], a[32:35]
    v_exp_f32 v162, v162
    v_mfma_f32_16x16x32_bf16 a[36:39], a[228:231], v[180:183], a[36:39]
    v_exp_f32 v163, v163
    v_mfma_f32_16x16x32_bf16 a[40:43], a[232:235], v[180:183], a[40:43]
    v_exp_f32 v164, v164
    v_mfma_f32_16x16x32_bf16 a[44:47], a[236:239], v[180:183], a[44:47]
    v_exp_f32 v165, v165
    v_mfma_f32_16x16x32_bf16 a[48:51], a[240:243], v[180:183], a[48:51]
    v_exp_f32 v166, v166
    v_mfma_f32_16x16x32_bf16 a[52:55], a[244:247], v[180:183], a[52:55]
    v_exp_f32 v167, v167
    v_mfma_f32_16x16x32_bf16 a[56:59], a[248:251], v[180:183], a[56:59]
    v_cvt_pk_bf16_f32 v192, v160, v161
    v_cvt_pk_bf16_f32 v193, v162, v163
    v_mfma_f32_16x16x32_bf16 a[60:63], a[252:255], v[180:183], a[60:63]
    v_cvt_pk_bf16_f32 v194, v164, v165
    v_cvt_pk_bf16_f32 v195, v166, v167
    s_waitcnt vmcnt(4)
    s_barrier
    v_mfma_f32_16x16x32_bf16 a[64:67], a[224:227], v[184:187], a[64:67]
    ds_read_b128 a[192:195], v4 offset:17408
    v_mfma_f32_16x16x32_bf16 a[68:71], a[228:231], v[184:187], a[68:71]
    ds_read_b128 a[196:199], v4 offset:17472
    v_mfma_f32_16x16x32_bf16 a[72:75], a[232:235], v[184:187], a[72:75]
    ds_read_b128 a[200:203], v4 offset:17536
    v_mfma_f32_16x16x32_bf16 a[76:79], a[236:239], v[184:187], a[76:79]
    ds_read_b128 a[204:207], v4 offset:17600
    v_mfma_f32_16x16x32_bf16 a[80:83], a[240:243], v[184:187], a[80:83]
    ds_read_b128 a[208:211], v4 offset:21760
    v_mfma_f32_16x16x32_bf16 a[84:87], a[244:247], v[184:187], a[84:87]
    ds_read_b128 a[212:215], v4 offset:21824
    v_mfma_f32_16x16x32_bf16 a[88:91], a[248:251], v[184:187], a[88:91]
    ds_read_b128 a[216:219], v4 offset:21888
    v_mfma_f32_16x16x32_bf16 a[92:95], a[252:255], v[184:187], a[92:95]
    ds_read_b128 a[220:223], v4 offset:21952
    v_mfma_f32_16x16x32_bf16 v[32:35], a[224:227], v[188:191], v[32:35]
    v_mfma_f32_16x16x32_bf16 v[36:39], a[228:231], v[188:191], v[36:39]
    v_mfma_f32_16x16x32_bf16 v[40:43], a[232:235], v[188:191], v[40:43]
    v_mfma_f32_16x16x32_bf16 v[44:47], a[236:239], v[188:191], v[44:47]
    v_mfma_f32_16x16x32_bf16 v[48:51], a[240:243], v[188:191], v[48:51]
    v_mfma_f32_16x16x32_bf16 v[52:55], a[244:247], v[188:191], v[52:55]
    v_mfma_f32_16x16x32_bf16 v[56:59], a[248:251], v[188:191], v[56:59]
    v_mfma_f32_16x16x32_bf16 v[60:63], a[252:255], v[188:191], v[60:63]
    s_waitcnt lgkmcnt(0)
    s_branch L_loop
L_wa:
    s_waitcnt vmcnt(4)
    s_cmp_gt_u32 s35, 3
    s_cbranch_scc1 L_wba
    s_waitcnt vmcnt(0)
    s_branch L_wba
L_dbl:
    v_mfma_f32_16x16x32_bf16 v[128:131], a[192:195], a[96:99], v[200:203]
    v_add_f32 v12, v12, v160
    v_cvt_pk_bf16_f32 v196, v168, v169
    v_mfma_f32_16x16x32_bf16 v[128:131], a[196:199], a[100:103], v[128:131]
    v_exp_f32 v170, v170
    v_mfma_f32_16x16x32_bf16 v[128:131], a[200:203], a[104:107], v[128:131]
    v_exp_f32 v171, v171
    v_mfma_f32_16x16x32_bf16 v[128:131], a[204:207], a[108:111], v[128:131]
    s_waitcnt lgkmcnt(0)
    v_add_f32 v12, v12, v161
    v_cvt_pk_bf16_f32 v197, v170, v171
    v_mfma_f32_16x16x32_bf16 v[132:135], a[208:211], a[96:99], v[200:203]
    v_exp_f32 v172, v172
    v_mfma_f32_16x16x32_bf16 v[132:135], a[212:215], a[100:103], v[132:135]
    v_exp_f32 v173, v173
    v_mfma_f32_16x16x32_bf16 v[132:135], a[216:219], a[104:107], v[132:135]
    v_add_f32 v12, v12, v162
    v_cvt_pk_bf16_f32 v198, v172, v173
    v_mfma_f32_16x16x32_bf16 v[132:135], a[220:223], a[108:111], v[132:135]
    v_exp_f32 v174, v174
    v_mfma_f32_16x16x32_bf16 v[64:67], a[224:227], v[192:195], v[64:67]
    s_add_u32 s37, s37, 8448
    v_exp_f32 v175, v175
    v_mfma_f32_16x16x32_bf16 v[68:71], a[228:231], v[192:195], v[68:71]
    s_cmp_eq_u32 s37, 67584
    v_add_f32 v12, v12, v163
    v_cvt_pk_bf16_f32 v199, v174, v175
    v_mfma_f32_16x16x32_bf16 v[72:75], a[232:235], v[192:195], v[72:75]
    s_cselect_b32 s37, 0, s37
    v_exp_f32 v128, v128
    v_mfma_f32_16x16x32_bf16 v[76:79], a[236:239], v[192:195], v[76:79]
    s_add_u32 s36, s36, 8704
    v_exp_f32 v129, v129
    v_mfma_f32_16x16x32_bf16 v[80:83], a[240:243], v[192:195], v[80:83]
    s_cmp_eq_u32 s36, 69632
    v_cvt_pk_bf16_f32 v176, v128, v129
    v_add_f32 v12, v12, v164
    v_mfma_f32_16x16x32_bf16 v[84:87], a[244:247], v[192:195], v[84:87]
    s_cselect_b32 s36, 0, s36
    v_exp_f32 v130, v130
    v_mfma_f32_16x16x32_bf16 v[88:91], a[248:251], v[192:195], v[88:91]
    v_exp_f32 v131, v131
    v_mfma_f32_16x16x32_bf16 v[92:95], a[252:255], v[192:195], v[92:95]
    v_lshl_add_u64 v[6:7], v[4:5], 0, s[36:37]
    v_cvt_pk_bf16_f32 v177, v130, v131
    v_mfma_f32_16x16x32_bf16 v[136:139], a[192:195], a[112:115], v[204:207]
    v_exp_f32 v132, v132
    v_mfma_f32_16x16x32_bf16 v[136:139], a[196:199], a[116:119], v[136:139]
    v_exp_f32 v133, v133
    v_mfma_f32_16x16x32_bf16 v[136:139], a[200:203], a[120:123], v[136:139]
    v_cvt_pk_bf16_f32 v178, v132, v133
    v_add_f32 v12, v12, v165
    v_mfma_f32_16x16x32_bf16 v[136:139], a[204:207], a[124:127], v[136:139]
    v_exp_f32 v134, v134
    v_mfma_f32_16x16x32_bf16 v[140:143], a[208:211], a[112:115], v[204:207]
    s_cmp_gt_u32 s35, 3
    v_exp_f32 v135, v135
    v_mfma_f32_16x16x32_bf16 v[140:143], a[212:215], a[116:119], v[140:143]
    s_cbranch_scc1 L_wb
    s_waitcnt vmcnt(0)
L_wb:
    v_mfma_f32_16x16x32_bf16 v[140:143], a[216:219], a[120:123], v[140:143]
    s_waitcnt vmcnt(4)
    v_cvt_pk_bf16_f32 v179, v134, v135
    v_add_f32 v12, v12, v166
    v_mfma_f32_16x16x32_bf16 v[140:143], a[220:223], a[124:127], v[140:143]
    s_barrier
    v_mfma_f32_16x16x32_bf16 v[96:99], a[224:227], v[196:199], v[96:99]
    ds_read_b64_tr_b16 a[224:225], v7 offset:0
    v_add_f32 v12, v12, v167
    v_mfma_f32_16x16x32_bf16 v[100:103], a[228:231], v[196:199], v[100:103]
    ds_read_b64_tr_b16 a[226:227], v7 offset:512
    v_add_f32 v13, v13, v168
    v_mfma_f32_16x16x32_bf16 v[104:107], a[232:235], v[196:199], v[104:107]
    ds_read_b64_tr_b16 a[228:229], v7 offset:32
    v_add_f32 v13, v13, v169
    v_mfma_f32_16x16x32_bf16 v[108:111], a[236:239], v[196:199], v[108:111]
    ds_read_b64_tr_b16 a[230:231], v7 offset:544
    v_add_f32 v13, v13, v170
    v_mfma_f32_16x16x32_bf16 v[112:115], a[240:243], v[196:199], v[112:115]
    ds_read_b64_tr_b16 a[232:233], v7 offset:64
    v_add_f32 v13, v13, v171
    v_mfma_f32_16x16x32_bf16 v[116:119], a[244:247], v[196:199], v[116:119]
    ds_read_b64_tr_b16 a[234:235], v7 offset:576
    v_add_f32 v13, v13, v172
    v_mfma_f32_16x16x32_bf16 v[120:123], a[248:251], v[196:199], v[120:123]
    ds_read_b64_tr_b16 a[236:237], v7 offset:96
    v_add_f32 v13, v13, v173
    v_mfma_f32_16x16x32_bf16 v[124:127], a[252:255], v[196:199], v[124:127]
    ds_read_b64_tr_b16 a[238:239], v7 offset:608
    v_add_f32 v13, v13, v174
    v_mfma_f32_16x16x32_bf16 v[144:147], a[192:195], a[128:131], v[208:211]
    ds_read_b64_tr_b16 a[240:241], v7 offset:128
    v_add_f32 v13, v13, v175
    v_mfma_f32_16x16x32_bf16 v[144:147], a[196:199], a[132:135], v[144:147]
    ds_read_b64_tr_b16 a[242:243], v7 offset:640
    v_mfma_f32_16x16x32_bf16 v[144:147], a[200:203], a[136:139], v[144:147]
    ds_read_b64_tr_b16 a[244:245], v7 offset:160
    v_mfma_f32_16x16x32_bf16 v[144:147], a[204:207], a[140:143], v[144:147]
    ds_read_b64_tr_b16 a[246:247], v7 offset:672
    v_exp_f32 v136, v136
    v_mfma_f32_16x16x32_bf16 v[148:151], a[208:211], a[128:131], v[208:211]
    ds_read_b64_tr_b16 a[248:249], v7 offset:192
    v_mfma_f32_16x16x32_bf16 v[148:151], a[212:215], a[132:135], v[148:151]
    ds_read_b64_tr_b16 a[250:251], v7 offset:704
    v_mfma_f32_16x16x32_bf16 v[148:151], a[216:219], a[136:139], v[148:151]
    ds_read_b64_tr_b16 a[252:253], v7 offset:224
    v_mfma_f32_16x16x32_bf16 v[148:151], a[220:223], a[140:143], v[148:151]
    s_waitcnt lgkmcnt(7)
    ds_read_b64_tr_b16 a[254:255], v7 offset:736
    v_mfma_f32_16x16x32_bf16 a[0:3], a[224:227], v[176:179], a[0:3]
    v_exp_f32 v137, v137
    v_mfma_f32_16x16x32_bf16 a[4:7], a[228:231], v[176:179], a[4:7]
    v_exp_f32 v138, v138
    v_mfma_f32_16x16x32_bf16 a[8:11], a[232:235], v[176:179], a[8:11]
    v_exp_f32 v139, v139
    v_mfma_f32_16x16x32_bf16 a[12:15], a[236:239], v[176:179], a[12:15]
    s_waitcnt lgkmcnt(0)
    v_exp_f32 v140, v140
    v_mfma_f32_16x16x32_bf16 a[16:19], a[240:243], v[176:179], a[16:19]
    s_mov_b32 m0, s39
    v_exp_f32 v141, v141
    v_mfma_f32_16x16x32_bf16 a[20:23], a[244:247], v[176:179], a[20:23]
    buffer_load_dwordx4 v3, s[24:27], s41 offen offset:0 nt lds
    v_mfma_f32_16x16x32_bf16 a[24:27], a[248:251], v[176:179], a[24:27]
    v_exp_f32 v142, v142
    v_mfma_f32_16x16x32_bf16 a[28:31], a[252:255], v[176:179], a[28:31]
    s_add_u32 m0, s39, 800
    v_exp_f32 v143, v143
    v_mfma_f32_16x16x32_bf16 v[20:23], v[28:31], v[176:179], v[20:23]
    buffer_load_dwordx4 v3, s[24:27], s41 offen offset:256 nt lds
    v_mfma_f32_16x16x32_bf16 v[152:155], a[192:195], a[144:147], v[212:215]
    v_exp_f32 v144, v144
    v_mfma_f32_16x16x32_bf16 v[152:155], a[196:199], a[148:151], v[152:155]
    s_mov_b32 m0, s38
    v_exp_f32 v145, v145
    v_mfma_f32_16x16x32_bf16 v[152:155], a[200:203], a[152:155], v[152:155]
    buffer_load_dwordx4 v2, s[20:23], s40 offen offset:0 nt lds
    v_mfma_f32_16x16x32_bf16 v[152:155], a[204:207], a[156:159], v[152:155]
    v_exp_f32 v146, v146
    v_mfma_f32_16x16x32_bf16 v[156:159], a[208:211], a[144:147], v[212:215]
    s_add_u32 m0, s38, 64
    v_cvt_pk_bf16_f32 v180, v136, v137
    v_cvt_pk_bf16_f32 v181, v138, v139
    v_mfma_f32_16x16x32_bf16 v[156:159], a[212:215], a[148:151], v[156:159]
    buffer_load_dwordx4 v2, s[20:23], s40 offen offset:1024 nt lds
    v_mfma_f32_16x16x32_bf16 v[156:159], a[216:219], a[152:155], v[156:159]
    s_add_u32 s39, s39, 8448
    v_cvt_pk_bf16_f32 v182, v140, v141
    v_cvt_pk_bf16_f32 v183, v142, v143
    v_mfma_f32_16x16x32_bf16 v[156:159], a[220:223], a[156:159], v[156:159]
    s_cmp_eq_u32 s39, s49
    v_exp_f32 v147, v147
    v_mfma_f32_16x16x32_bf16 a[32:35], a[224:227], v[180:183], a[32:35]
    s_cselect_b32 s39, s43, s39
    v_exp_f32 v148, v148
    v_mfma_f32_16x16x32_bf16 a[36:39], a[228:231], v[180:183], a[36:39]
    s_add_u32 s38, s38, 8704
    v_exp_f32 v149, v149
    v_mfma_f32_16x16x32_bf16 a[40:43], a[232:235], v[180:183], a[40:43]
    s_cmp_eq_u32 s38, s48
    v_cvt_pk_bf16_f32 v184, v144, v145
    v_cvt_pk_bf16_f32 v185, v146, v147
    v_mfma_f32_16x16x32_bf16 a[44:47], a[236:239], v[180:183], a[44:47]
    s_cselect_b32 s38, s42, s38
    v_exp_f32 v150, v150
    v_mfma_f32_16x16x32_bf16 a[48:51], a[240:243], v[180:183], a[48:51]
    s_add_u32 s41, s41, 8192
    v_add_f32 v10, v10, v144
    v_cvt_pk_bf16_f32 v186, v148, v149
    v_mfma_f32_16x16x32_bf16 a[52:55], a[244:247], v[180:183], a[52:55]
    s_add_u32 s40, s40, 8192
    v_exp_f32 v151, v151
    v_mfma_f32_16x16x32_bf16 a[56:59], a[248:251], v[180:183], a[56:59]
    s_cmp_lt_u32 s41, s44
    v_add_f32 v10, v10, v145
    v_cvt_pk_bf16_f32 v187, v150, v151
    v_mfma_f32_16x16x32_bf16 a[60:63], a[252:255], v[180:183], a[60:63]
    s_cselect_b32 s26, s44, 0
    v_exp_f32 v152, v152
    v_mfma_f32_16x16x32_bf16 v[24:27], v[28:31], v[180:183], v[24:27]
    s_cmp_lt_u32 s40, s44
    v_exp_f32 v153, v153
    v_mfma_f32_16x16x32_bf16 v[160:163], a[192:195], a[160:163], v[216:219]
    s_cselect_b32 s22, s44, 0
    v_add_f32 v10, v10, v146
    v_cvt_pk_bf16_f32 v188, v152, v153
    v_mfma_f32_16x16x32_bf16 v[160:163], a[196:199], a[164:167], v[160:163]
    s_mov_b32 m0, s39
    v_exp_f32 v154, v154
    v_mfma_f32_16x16x32_bf16 v[160:163], a[200:203], a[168:171], v[160:163]
    buffer_load_dwordx4 v3, s[24:27], s41 offen offset:0 nt lds
    v_exp_f32 v155, v155
    v_mfma_f32_16x16x32_bf16 v[160:163], a[204:207], a[172:175], v[160:163]
    s_add_u32 m0, s39, 800
    v_add_f32 v10, v10, v147
    v_cvt_pk_bf16_f32 v189, v154, v155
    v_mfma_f32_16x16x32_bf16 v[164:167], a[208:211], a[160:163], v[216:219]
    buffer_load_dwordx4 v3, s[24:27], s41 offen offset:256 nt lds
    v_exp_f32 v156, v156
    v_mfma_f32_16x16x32_bf16 v[164:167], a[212:215], a[164:167], v[164:167]
    s_mov_b32 m0, s38
    v_exp_f32 v157, v157
    v_mfma_f32_16x16x32_bf16 v[164:167], a[216:219], a[168:171], v[164:167]
    buffer_load_dwordx4 v2, s[20:23], s40 offen offset:0 nt lds
    v_add_f32 v10, v10, v148
    v_cvt_pk_bf16_f32 v190, v156, v157
    v_mfma_f32_16x16x32_bf16 v[164:167], a[220:223], a[172:175], v[164:167]
    s_add_u32 m0, s38, 64
    v_exp_f32 v158, v158
    v_mfma_f32_16x16x32_bf16 a[64:67], a[224:227], v[184:187], a[64:67]
    buffer_load_dwordx4 v2, s[20:23], s40 offen offset:1024 nt lds
    v_exp_f32 v159, v159
    v_mfma_f32_16x16x32_bf16 a[68:71], a[228:231], v[184:187], a[68:71]
    s_add_u32 s39, s39, 8448
    v_add_f32 v10, v10, v149
    v_cvt_pk_bf16_f32 v191, v158, v159
    v_mfma_f32_16x16x32_bf16 a[72:75], a[232:235], v[184:187], a[72:75]
    s_cmp_eq_u32 s39, s49
    v_add_f32 v10, v10, v150
    v_add_f32 v10, v10, v151
    v_mfma_f32_16x16x32_bf16 a[76:79], a[236:239], v[184:187], a[76:79]
    s_cselect_b32 s39, s43, s39
    v_exp_f32 v160, v160
    v_mfma_f32_16x16x32_bf16 a[80:83], a[240:243], v[184:187], a[80:83]
    s_add_u32 s38, s38, 8704
    v_exp_f32 v161, v161
    v_mfma_f32_16x16x32_bf16 a[84:87], a[244:247], v[184:187], a[84:87]
    s_cmp_eq_u32 s38, s48
    v_add_f32 v11, v11, v152
    v_cvt_pk_bf16_f32 v192, v160, v161
    v_mfma_f32_16x16x32_bf16 a[88:91], a[248:251], v[184:187], a[88:91]
    s_cselect_b32 s38, s42, s38
    v_exp_f32 v162, v162
    v_mfma_f32_16x16x32_bf16 a[92:95], a[252:255], v[184:187], a[92:95]
    s_add_u32 s41, s41, 8192
    v_exp_f32 v163, v163
    v_mfma_f32_16x16x32_bf16 v[168:171], a[192:195], a[176:179], v[220:223]
    s_add_u32 s40, s40, 8192
    ds_read_b128 a[192:195], v6 offset:0
    v_cvt_pk_bf16_f32 v193, v162, v163
    v_mfma_f32_16x16x32_bf16 v[168:171], a[196:199], a[180:183], v[168:171]
    s_cmp_lt_u32 s41, s44
    ds_read_b128 a[196:199], v6 offset:64
    v_add_f32 v11, v11, v153
    v_mfma_f32_16x16x32_bf16 v[168:171], a[200:203], a[184:187], v[168:171]
    s_cselect_b32 s26, s44, 0
    v_exp_f32 v164, v164
    v_mfma_f32_16x16x32_bf16 v[168:171], a[204:207], a[188:191], v[168:171]
    s_cmp_lt_u32 s40, s44
    ds_read_b128 a[200:203], v6 offset:128
    v_add_f32 v11, v11, v154
    v_mfma_f32_16x16x32_bf16 v[172:175], a[208:211], a[176:179], v[220:223]
    s_cselect_b32 s22, s44, 0
    ds_read_b128 a[204:207], v6 offset:192
    v_add_f32 v11, v11, v155
    v_mfma_f32_16x16x32_bf16 v[172:175], a[212:215], a[180:183], v[172:175]
    v_exp_f32 v165, v165
    v_mfma_f32_16x16x32_bf16 v[172:175], a[216:219], a[184:187], v[172:175]
    ds_read_b128 a[208:211], v6 offset:4352
    v_cvt_pk_bf16_f32 v194, v164, v165
    v_mfma_f32_16x16x32_bf16 v[172:175], a[220:223], a[188:191], v[172:175]
    ds_read_b128 a[212:215], v6 offset:4416
    v_add_f32 v11, v11, v156
    v_mfma_f32_16x16x32_bf16 v[32:35], a[224:227], v[188:191], v[32:35]
    v_exp_f32 v166, v166
    v_mfma_f32_16x16x32_bf16 v[36:39], a[228:231], v[188:191], v[36:39]
    ds_read_b128 a[216:219], v6 offset:4480
    v_add_f32 v11, v11, v157
    v_mfma_f32_16x16x32_bf16 v[40:43], a[232:235], v[188:191], v[40:43]
    ds_read_b128 a[220:223], v6 offset:4544
    v_add_f32 v11, v11, v158
    v_mfma_f32_16x16x32_bf16 v[44:47], a[236:239], v[188:191], v[44:47]
    s_add_u32 s35, s35, 1
    v_exp_f32 v167, v167
    v_mfma_f32_16x16x32_bf16 v[48:51], a[240:243], v[188:191], v[48:51]
    s_bitcmp1_b32 s33, s35
    v_add_f32 v11, v11, v159
    v_cvt_pk_bf16_f32 v195, v166, v167
    v_mfma_f32_16x16x32_bf16 v[52:55], a[244:247], v[188:191], v[52:55]
    v_exp_f32 v168, v168
    v_mfma_f32_16x16x32_bf16 v[56:59], a[248:251], v[188:191], v[56:59]
    s_waitcnt lgkmcnt(3)
    v_exp_f32 v169, v169
    v_mfma_f32_16x16x32_bf16 v[60:63], a[252:255], v[188:191], v[60:63]
.p2align 3
L_loop:
    v_mfma_f32_16x16x32_bf16 v[128:131], a[192:195], a[96:99], v[200:203]
    v_add_f32 v12, v12, v160
    v_cvt_pk_bf16_f32 v196, v168, v169
    v_mfma_f32_16x16x32_bf16 v[128:131], a[196:199], a[100:103], v[128:131]
    v_exp_f32 v170, v170
    v_mfma_f32_16x16x32_bf16 v[128:131], a[200:203], a[104:107], v[128:131]
    v_exp_f32 v171, v171
    v_mfma_f32_16x16x32_bf16 v[128:131], a[204:207], a[108:111], v[128:131]
    s_waitcnt lgkmcnt(0)
    v_add_f32 v12, v12, v161
    v_cvt_pk_bf16_f32 v197, v170, v171
    v_mfma_f32_16x16x32_bf16 v[132:135], a[208:211], a[96:99], v[200:203]
    v_exp_f32 v172, v172
    v_mfma_f32_16x16x32_bf16 v[132:135], a[212:215], a[100:103], v[132:135]
    v_exp_f32 v173, v173
    v_mfma_f32_16x16x32_bf16 v[132:135], a[216:219], a[104:107], v[132:135]
    v_add_f32 v12, v12, v162
    v_cvt_pk_bf16_f32 v198, v172, v173
    v_mfma_f32_16x16x32_bf16 v[132:135], a[220:223], a[108:111], v[132:135]
    v_exp_f32 v174, v174
    v_mfma_f32_16x16x32_bf16 v[64:67], a[224:227], v[192:195], v[64:67]
    s_add_u32 s37, s37, 8448
    v_exp_f32 v175, v175
    v_mfma_f32_16x16x32_bf16 v[68:71], a[228:231], v[192:195], v[68:71]
    s_cmp_eq_u32 s37, 67584
    v_add_f32 v12, v12, v163
    v_cvt_pk_bf16_f32 v199, v174, v175
    v_mfma_f32_16x16x32_bf16 v[72:75], a[232:235], v[192:195], v[72:75]
    s_cselect_b32 s37, 0, s37
    v_exp_f32 v128, v128
    v_mfma_f32_16x16x32_bf16 v[76:79], a[236:239], v[192:195], v[76:79]
    s_add_u32 s36, s36, 8704
    v_exp_f32 v129, v129
    v_mfma_f32_16x16x32_bf16 v[80:83], a[240:243], v[192:195], v[80:83]
    s_cmp_eq_u32 s36, 69632
    v_cvt_pk_bf16_f32 v176, v128, v129
    v_add_f32 v12, v12, v164
    v_mfma_f32_16x16x32_bf16 v[84:87], a[244:247], v[192:195], v[84:87]
    s_cselect_b32 s36, 0, s36
    v_exp_f32 v130, v130
    v_mfma_f32_16x16x32_bf16 v[88:91], a[248:251], v[192:195], v[88:91]
    v_exp_f32 v131, v131
    v_mfma_f32_16x16x32_bf16 v[92:95], a[252:255], v[192:195], v[92:95]
    v_lshl_add_u64 v[6:7], v[4:5], 0, s[36:37]
    v_cvt_pk_bf16_f32 v177, v130, v131
    v_mfma_f32_16x16x32_bf16 v[136:139], a[192:195], a[112:115], v[204:207]
    v_exp_f32 v132, v132
    v_mfma_f32_16x16x32_bf16 v[136:139], a[196:199], a[116:119], v[136:139]
    v_exp_f32 v133, v133
    v_mfma_f32_16x16x32_bf16 v[136:139], a[200:203], a[120:123], v[136:139]
    v_cvt_pk_bf16_f32 v178, v132, v133
    v_add_f32 v12, v12, v165
    v_mfma_f32_16x16x32_bf16 v[136:139], a[204:207], a[124:127], v[136:139]
    v_exp_f32 v134, v134
    v_mfma_f32_16x16x32_bf16 v[140:143], a[208:211], a[112:115], v[204:207]
    s_cmp_le_u32 s35, 6
    v_exp_f32 v135, v135
    v_mfma_f32_16x16x32_bf16 v[140:143], a[212:215], a[116:119], v[140:143]
    s_cbranch_scc1 L_wa
L_wba:
    v_mfma_f32_16x16x32_bf16 v[140:143], a[216:219], a[120:123], v[140:143]
    s_waitcnt vmcnt(8)
    v_cvt_pk_bf16_f32 v179, v134, v135
    v_add_f32 v12, v12, v166
    v_mfma_f32_16x16x32_bf16 v[140:143], a[220:223], a[124:127], v[140:143]
    s_barrier
    v_mfma_f32_16x16x32_bf16 v[96:99], a[224:227], v[196:199], v[96:99]
    ds_read_b64_tr_b16 a[224:225], v7 offset:0
    v_add_f32 v12, v12, v167
    v_mfma_f32_16x16x32_bf16 v[100:103], a[228:231], v[196:199], v[100:103]
    ds_read_b64_tr_b16 a[226:227], v7 offset:512
    v_add_f32 v13, v13, v168
    v_mfma_f32_16x16x32_bf16 v[104:107], a[232:235], v[196:199], v[104:107]
    ds_read_b64_tr_b16 a[228:229], v7 offset:32
    v_add_f32 v13, v13, v169
    v_mfma_f32_16x16x32_bf16 v[108:111], a[236:239], v[196:199], v[108:111]
    ds_read_b64_tr_b16 a[230:231], v7 offset:544
    v_add_f32 v13, v13, v170
    v_mfma_f32_16x16x32_bf16 v[112:115], a[240:243], v[196:199], v[112:115]
    ds_read_b64_tr_b16 a[232:233], v7 offset:64
    v_add_f32 v13, v13, v171
    v_mfma_f32_16x16x32_bf16 v[116:119], a[244:247], v[196:199], v[116:119]
    ds_read_b64_tr_b16 a[234:235], v7 offset:576
    v_add_f32 v13, v13, v172
    v_mfma_f32_16x16x32_bf16 v[120:123], a[248:251], v[196:199], v[120:123]
    ds_read_b64_tr_b16 a[236:237], v7 offset:96
    v_add_f32 v13, v13, v173
    v_mfma_f32_16x16x32_bf16 v[124:127], a[252:255], v[196:199], v[124:127]
    ds_read_b64_tr_b16 a[238:239], v7 offset:608
    v_add_f32 v13, v13, v174
    v_mfma_f32_16x16x32_bf16 v[144:147], a[192:195], a[128:131], v[208:211]
    ds_read_b64_tr_b16 a[240:241], v7 offset:128
    v_add_f32 v13, v13, v175
    v_mfma_f32_16x16x32_bf16 v[144:147], a[196:199], a[132:135], v[144:147]
    ds_read_b64_tr_b16 a[242:243], v7 offset:640
    v_mfma_f32_16x16x32_bf16 v[144:147], a[200:203], a[136:139], v[144:147]
    ds_read_b64_tr_b16 a[244:245], v7 offset:160
    v_mfma_f32_16x16x32_bf16 v[144:147], a[204:207], a[140:143], v[144:147]
    ds_read_b64_tr_b16 a[246:247], v7 offset:672
    v_exp_f32 v136, v136
    v_mfma_f32_16x16x32_bf16 v[148:151], a[208:211], a[128:131], v[208:211]
    ds_read_b64_tr_b16 a[248:249], v7 offset:192
    v_mfma_f32_16x16x32_bf16 v[148:151], a[212:215], a[132:135], v[148:151]
    ds_read_b64_tr_b16 a[250:251], v7 offset:704
    v_mfma_f32_16x16x32_bf16 v[148:151], a[216:219], a[136:139], v[148:151]
    ds_read_b64_tr_b16 a[252:253], v7 offset:224
    v_mfma_f32_16x16x32_bf16 v[148:151], a[220:223], a[140:143], v[148:151]
    s_waitcnt lgkmcnt(7)
    ds_read_b64_tr_b16 a[254:255], v7 offset:736
    v_mfma_f32_16x16x32_bf16 a[0:3], a[224:227], v[176:179], a[0:3]
    v_exp_f32 v137, v137
    v_mfma_f32_16x16x32_bf16 a[4:7], a[228:231], v[176:179], a[4:7]
    v_exp_f32 v138, v138
    v_mfma_f32_16x16x32_bf16 a[8:11], a[232:235], v[176:179], a[8:11]
    v_exp_f32 v139, v139
    v_mfma_f32_16x16x32_bf16 a[12:15], a[236:239], v[176:179], a[12:15]
    s_waitcnt lgkmcnt(0)
    v_exp_f32 v140, v140
    v_mfma_f32_16x16x32_bf16 a[16:19], a[240:243], v[176:179], a[16:19]
    s_mov_b32 m0, s39
    v_exp_f32 v141, v141
    v_mfma_f32_16x16x32_bf16 a[20:23], a[244:247], v[176:179], a[20:23]
    buffer_load_dwordx4 v3, s[24:27], s41 offen offset:0 nt lds
    v_mfma_f32_16x16x32_bf16 a[24:27], a[248:251], v[176:179], a[24:27]
    v_exp_f32 v142, v142
    v_mfma_f32_16x16x32_bf16 a[28:31], a[252:255], v[176:179], a[28:31]
    s_add_u32 m0, s39, 800
    v_exp_f32 v143, v143
    v_mfma_f32_16x16x32_bf16 v[20:23], v[28:31], v[176:179], v[20:23]
    buffer_load_dwordx4 v3, s[24:27], s41 offen offset:256 nt lds
    v_mfma_f32_16x16x32_bf16 v[152:155], a[192:195], a[144:147], v[212:215]
    v_exp_f32 v144, v144
    v_mfma_f32_16x16x32_bf16 v[152:155], a[196:199], a[148:151], v[152:155]
    s_mov_b32 m0, s38
    v_exp_f32 v145, v145
    v_mfma_f32_16x16x32_bf16 v[152:155], a[200:203], a[152:155], v[152:155]
    buffer_load_dwordx4 v2, s[20:23], s40 offen offset:0 nt lds
    v_mfma_f32_16x16x32_bf16 v[152:155], a[204:207], a[156:159], v[152:155]
    v_exp_f32 v146, v146
    v_mfma_f32_16x16x32_bf16 v[156:159], a[208:211], a[144:147], v[212:215]
    s_add_u32 m0, s38, 64
    v_cvt_pk_bf16_f32 v180, v136, v137
    v_cvt_pk_bf16_f32 v181, v138, v139
    v_mfma_f32_16x16x32_bf16 v[156:159], a[212:215], a[148:151], v[156:159]
    buffer_load_dwordx4 v2, s[20:23], s40 offen offset:1024 nt lds
    v_mfma_f32_16x16x32_bf16 v[156:159], a[216:219], a[152:155], v[156:159]
    s_add_u32 s39, s39, 8448
    v_cvt_pk_bf16_f32 v182, v140, v141
    v_cvt_pk_bf16_f32 v183, v142, v143
    v_mfma_f32_16x16x32_bf16 v[156:159], a[220:223], a[156:159], v[156:159]
    s_cmp_eq_u32 s39, s49
    v_exp_f32 v147, v147
    v_mfma_f32_16x16x32_bf16 a[32:35], a[224:227], v[180:183], a[32:35]
    s_cselect_b32 s39, s43, s39
    v_exp_f32 v148, v148
    v_mfma_f32_16x16x32_bf16 a[36:39], a[228:231], v[180:183], a[36:39]
    s_add_u32 s38, s38, 8704
    v_exp_f32 v149, v149
    v_mfma_f32_16x16x32_bf16 a[40:43], a[232:235], v[180:183], a[40:43]
    s_cmp_eq_u32 s38, s48
    v_cvt_pk_bf16_f32 v184, v144, v145
    v_cvt_pk_bf16_f32 v185, v146, v147
    v_mfma_f32_16x16x32_bf16 a[44:47], a[236:239], v[180:183], a[44:47]
    s_cselect_b32 s38, s42, s38
    v_exp_f32 v150, v150
    v_mfma_f32_16x16x32_bf16 a[48:51], a[240:243], v[180:183], a[48:51]
    s_add_u32 s41, s41, 8192
    v_add_f32 v10, v10, v144
    v_cvt_pk_bf16_f32 v186, v148, v149
    v_mfma_f32_16x16x32_bf16 a[52:55], a[244:247], v[180:183], a[52:55]
    s_add_u32 s40, s40, 8192
    v_exp_f32 v151, v151
    v_mfma_f32_16x16x32_bf16 a[56:59], a[248:251], v[180:183], a[56:59]
    s_cmp_lt_u32 s41, s44
    v_add_f32 v10, v10, v145
    v_cvt_pk_bf16_f32 v187, v150, v151
    v_mfma_f32_16x16x32_bf16 a[60:63], a[252:255], v[180:183], a[60:63]
    s_cselect_b32 s26, s44, 0
    v_exp_f32 v152, v152
    v_mfma_f32_16x16x32_bf16 v[24:27], v[28:31], v[180:183], v[24:27]
    s_cmp_lt_u32 s40, s44
    v_exp_f32 v153, v153
    v_mfma_f32_16x16x32_bf16 v[160:163], a[192:195], a[160:163], v[216:219]
    s_cselect_b32 s22, s44, 0
    v_add_f32 v10, v10, v146
    v_cvt_pk_bf16_f32 v188, v152, v153
    v_mfma_f32_16x16x32_bf16 v[160:163], a[196:199], a[164:167], v[160:163]
    v_exp_f32 v154, v154
    v_mfma_f32_16x16x32_bf16 v[160:163], a[200:203], a[168:171], v[160:163]
    v_exp_f32 v155, v155
    v_mfma_f32_16x16x32_bf16 v[160:163], a[204:207], a[172:175], v[160:163]
    v_add_f32 v10, v10, v147
    v_cvt_pk_bf16_f32 v189, v154, v155
    v_mfma_f32_16x16x32_bf16 v[164:167], a[208:211], a[160:163], v[216:219]
    v_exp_f32 v156, v156
    v_mfma_f32_16x16x32_bf16 v[164:167], a[212:215], a[164:167], v[164:167]
    v_exp_f32 v157, v157
    v_mfma_f32_16x16x32_bf16 v[164:167], a[216:219], a[168:171], v[164:167]
    v_add_f32 v10, v10, v148
    v_cvt_pk_bf16_f32 v190, v156, v157
    v_mfma_f32_16x16x32_bf16 v[164:167], a[220:223], a[172:175], v[164:167]
    v_exp_f32 v158, v158
    v_mfma_f32_16x16x32_bf16 a[64:67], a[224:227], v[184:187], a[64:67]
    v_exp_f32 v159, v159
    v_mfma_f32_16x16x32_bf16 a[68:71], a[228:231], v[184:187], a[68:71]
    v_add_f32 v10, v10, v149
    v_cvt_pk_bf16_f32 v191, v158, v159
    v_mfma_f32_16x16x32_bf16 a[72:75], a[232:235], v[184:187], a[72:75]
    v_add_f32 v10, v10, v150
    v_add_f32 v10, v10, v151
    v_mfma_f32_16x16x32_bf16 a[76:79], a[236:239], v[184:187], a[76:79]
    v_exp_f32 v160, v160
    v_mfma_f32_16x16x32_bf16 a[80:83], a[240:243], v[184:187], a[80:83]
    v_exp_f32 v161, v161
    v_mfma_f32_16x16x32_bf16 a[84:87], a[244:247], v[184:187], a[84:87]
    v_add_f32 v11, v11, v152
    v_cvt_pk_bf16_f32 v192, v160, v161
    v_mfma_f32_16x16x32_bf16 a[88:91], a[248:251], v[184:187], a[88:91]
    v_exp_f32 v162, v162
    v_mfma_f32_16x16x32_bf16 a[92:95], a[252:255], v[184:187], a[92:95]
    v_exp_f32 v163, v163
    v_mfma_f32_16x16x32_bf16 v[168:171], a[192:195], a[176:179], v[220:223]
    ds_read_b128 a[192:195], v6 offset:0
    v_cvt_pk_bf16_f32 v193, v162, v163
    v_mfma_f32_16x16x32_bf16 v[168:171], a[196:199], a[180:183], v[168:171]
    ds_read_b128 a[196:199], v6 offset:64
    v_add_f32 v11, v11, v153
    v_mfma_f32_16x16x32_bf16 v[168:171], a[200:203], a[184:187], v[168:171]
    v_exp_f32 v164, v164
    v_mfma_f32_16x16x32_bf16 v[168:171], a[204:207], a[188:191], v[168:171]
    ds_read_b128 a[200:203], v6 offset:128
    v_add_f32 v11, v11, v154
    v_mfma_f32_16x16x32_bf16 v[172:175], a[208:211], a[176:179], v[220:223]
    ds_read_b128 a[204:207], v6 offset:192
    v_add_f32 v11, v11, v155
    v_mfma_f32_16x16x32_bf16 v[172:175], a[212:215], a[180:183], v[172:175]
    v_exp_f32 v165, v165
    v_mfma_f32_16x16x32_bf16 v[172:175], a[216:219], a[184:187], v[172:175]
    ds_read_b128 a[208:211], v6 offset:4352
    v_cvt_pk_bf16_f32 v194, v164, v165
    v_mfma_f32_16x16x32_bf16 v[172:175], a[220:223], a[188:191], v[172:175]
    ds_read_b128 a[212:215], v6 offset:4416
    v_add_f32 v11, v11, v156
    v_mfma_f32_16x16x32_bf16 v[32:35], a[224:227], v[188:191], v[32:35]
    v_exp_f32 v166, v166
    v_mfma_f32_16x16x32_bf16 v[36:39], a[228:231], v[188:191], v[36:39]
    ds_read_b128 a[216:219], v6 offset:4480
    v_add_f32 v11, v11, v157
    v_mfma_f32_16x16x32_bf16 v[40:43], a[232:235], v[188:191], v[40:43]
    ds_read_b128 a[220:223], v6 offset:4544
    v_add_f32 v11, v11, v158
    v_mfma_f32_16x16x32_bf16 v[44:47], a[236:239], v[188:191], v[44:47]
    s_add_u32 s35, s35, 1
    v_exp_f32 v167, v167
    v_mfma_f32_16x16x32_bf16 v[48:51], a[240:243], v[188:191], v[48:51]
    s_bitcmp1_b32 s33, s35
    v_add_f32 v11, v11, v159
    v_cvt_pk_bf16_f32 v195, v166, v167
    v_mfma_f32_16x16x32_bf16 v[52:55], a[244:247], v[188:191], v[52:55]
    v_exp_f32 v168, v168
    v_mfma_f32_16x16x32_bf16 v[56:59], a[248:251], v[188:191], v[56:59]
    s_waitcnt lgkmcnt(3)
    v_exp_f32 v169, v169
    v_mfma_f32_16x16x32_bf16 v[60:63], a[252:255], v[188:191], v[60:63]
    s_cbranch_scc1 L_loop
    s_cmp_le_u32 s35, 12
    s_cbranch_scc1 L_dbl
    v_mfma_f32_16x16x32_bf16 v[128:131], a[192:195], a[96:99], v[200:203]
    s_waitcnt vmcnt(4)
    v_exp_f32 v170, v170
    v_mfma_f32_16x16x32_bf16 v[136:139], a[192:195], a[112:115], v[204:207]
    s_barrier
    v_exp_f32 v171, v171
    v_mfma_f32_16x16x32_bf16 v[128:131], a[196:199], a[100:103], v[128:131]
    s_waitcnt lgkmcnt(0)
    ds_read_b128 a[192:195], v4 offset:52224
    v_cvt_pk_bf16_f32 v196, v168, v169
    v_mfma_f32_16x16x32_bf16 v[136:139], a[196:199], a[116:119], v[136:139]
    ds_read_b128 a[196:199], v4 offset:52288
    v_cvt_pk_bf16_f32 v197, v170, v171
    v_mfma_f32_16x16x32_bf16 v[128:131], a[200:203], a[104:107], v[128:131]
    v_exp_f32 v172, v172
    v_mfma_f32_16x16x32_bf16 v[136:139], a[200:203], a[120:123], v[136:139]
    ds_read_b128 a[200:203], v4 offset:52352
    v_add_f32 v12, v12, v160
    v_mfma_f32_16x16x32_bf16 v[128:131], a[204:207], a[108:111], v[128:131]
    v_exp_f32 v173, v173
    v_mfma_f32_16x16x32_bf16 v[136:139], a[204:207], a[124:127], v[136:139]
    ds_read_b128 a[204:207], v4 offset:52416
    v_exp_f32 v174, v174
    v_mfma_f32_16x16x32_bf16 v[132:135], a[208:211], a[96:99], v[200:203]
    v_exp_f32 v175, v175
    v_mfma_f32_16x16x32_bf16 v[140:143], a[208:211], a[112:115], v[204:207]
    ds_read_b128 a[208:211], v4 offset:56576
    v_cvt_pk_bf16_f32 v198, v172, v173
    v_mfma_f32_16x16x32_bf16 v[132:135], a[212:215], a[100:103], v[132:135]
    v_exp_f32 v128, v128
    v_mfma_f32_16x16x32_bf16 v[140:143], a[212:215], a[116:119], v[140:143]
    ds_read_b128 a[212:215], v4 offset:56640
    v_cvt_pk_bf16_f32 v199, v174, v175
    v_mfma_f32_16x16x32_bf16 v[132:135], a[216:219], a[104:107], v[132:135]
    v_exp_f32 v129, v129
    v_mfma_f32_16x16x32_bf16 v[140:143], a[216:219], a[120:123], v[140:143]
    ds_read_b128 a[216:219], v4 offset:56704
    v_exp_f32 v130, v130
    v_mfma_f32_16x16x32_bf16 v[132:135], a[220:223], a[108:111], v[132:135]
    v_exp_f32 v131, v131
    v_mfma_f32_16x16x32_bf16 v[140:143], a[220:223], a[124:127], v[140:143]
    ds_read_b128 a[220:223], v4 offset:56768
    v_cvt_pk_bf16_f32 v176, v128, v129
    v_mfma_f32_16x16x32_bf16 v[64:67], a[224:227], v[192:195], v[64:67]
    v_exp_f32 v136, v136
    v_mfma_f32_16x16x32_bf16 v[68:71], a[228:231], v[192:195], v[68:71]
    v_exp_f32 v137, v137
    v_mfma_f32_16x16x32_bf16 v[72:75], a[232:235], v[192:195], v[72:75]
    v_exp_f32 v132, v132
    v_mfma_f32_16x16x32_bf16 v[76:79], a[236:239], v[192:195], v[76:79]
    v_exp_f32 v133, v133
    v_mfma_f32_16x16x32_bf16 v[80:83], a[240:243], v[192:195], v[80:83]
    v_exp_f32 v134, v134
    v_mfma_f32_16x16x32_bf16 v[84:87], a[244:247], v[192:195], v[84:87]
    v_exp_f32 v135, v135
    v_mfma_f32_16x16x32_bf16 v[88:91], a[248:251], v[192:195], v[88:91]
    v_exp_f32 v138, v138
    v_mfma_f32_16x16x32_bf16 v[92:95], a[252:255], v[192:195], v[92:95]
    v_exp_f32 v139, v139
    v_mfma_f32_16x16x32_bf16 v[96:99], a[224:227], v[196:199], v[96:99]
    ds_read_b64_tr_b16 a[224:225], v5 offset:42240
    v_cvt_pk_bf16_f32 v177, v130, v131
    v_mfma_f32_16x16x32_bf16 v[100:103], a[228:231], v[196:199], v[100:103]
    ds_read_b64_tr_b16 a[226:227], v5 offset:42752
    v_cvt_pk_bf16_f32 v178, v132, v133
    v_mfma_f32_16x16x32_bf16 v[104:107], a[232:235], v[196:199], v[104:107]
    ds_read_b64_tr_b16 a[228:229], v5 offset:42272
    v_exp_f32 v140, v140
    v_mfma_f32_16x16x32_bf16 v[108:111], a[236:239], v[196:199], v[108:111]
    ds_read_b64_tr_b16 a[230:231], v5 offset:42784
    v_cvt_pk_bf16_f32 v179, v134, v135
    v_mfma_f32_16x16x32_bf16 v[112:115], a[240:243], v[196:199], v[112:115]
    ds_read_b64_tr_b16 a[232:233], v5 offset:42304
    v_cvt_pk_bf16_f32 v180, v136, v137
    v_mfma_f32_16x16x32_bf16 v[116:119], a[244:247], v[196:199], v[116:119]
    ds_read_b64_tr_b16 a[234:235], v5 offset:42816
    v_exp_f32 v141, v141
    v_mfma_f32_16x16x32_bf16 v[120:123], a[248:251], v[196:199], v[120:123]
    ds_read_b64_tr_b16 a[236:237], v5 offset:42336
    v_cvt_pk_bf16_f32 v181, v138, v139
    v_mfma_f32_16x16x32_bf16 v[124:127], a[252:255], v[196:199], v[124:127]
    s_waitcnt lgkmcnt(8)
    ds_read_b64_tr_b16 a[238:239], v5 offset:42848
    v_cvt_pk_bf16_f32 v182, v140, v141
    v_mfma_f32_16x16x32_bf16 v[144:147], a[192:195], a[96:99], v[200:203]
    ds_read_b64_tr_b16 a[240:241], v5 offset:42368
    v_exp_f32 v142, v142
    v_mfma_f32_16x16x32_bf16 v[152:155], a[192:195], a[112:115], v[204:207]
    ds_read_b64_tr_b16 a[242:243], v5 offset:42880
    v_add_f32 v12, v12, v161
    v_mfma_f32_16x16x32_bf16 v[144:147], a[196:199], a[100:103], v[144:147]
    ds_read_b64_tr_b16 a[244:245], v5 offset:42400
    v_add_f32 v12, v12, v162
    v_mfma_f32_16x16x32_bf16 v[152:155], a[196:199], a[116:119], v[152:155]
    ds_read_b64_tr_b16 a[246:247], v5 offset:42912
    v_add_f32 v12, v12, v163
    v_mfma_f32_16x16x32_bf16 v[144:147], a[200:203], a[104:107], v[144:147]
    ds_read_b64_tr_b16 a[248:249], v5 offset:42432
    v_exp_f32 v143, v143
    v_mfma_f32_16x16x32_bf16 v[152:155], a[200:203], a[120:123], v[152:155]
    ds_read_b64_tr_b16 a[250:251], v5 offset:42944
    v_cvt_pk_bf16_f32 v183, v142, v143
    v_mfma_f32_16x16x32_bf16 v[144:147], a[204:207], a[108:111], v[144:147]
    ds_read_b64_tr_b16 a[252:253], v5 offset:42464
    v_add_f32 v12, v12, v164
    v_mfma_f32_16x16x32_bf16 v[152:155], a[204:207], a[124:127], v[152:155]
    ds_read_b64_tr_b16 a[254:255], v5 offset:42976
    v_add_f32 v12, v12, v165
    v_add_f32 v12, v12, v166
    v_mfma_f32_16x16x32_bf16 v[148:151], a[208:211], a[96:99], v[200:203]
    ds_read_b128 a[192:195], v4 offset:60928
    v_add_f32 v12, v12, v167
    v_mfma_f32_16x16x32_bf16 v[156:159], a[208:211], a[112:115], v[204:207]
    ds_read_b128 a[196:199], v4 offset:60992
    v_add_f32 v13, v13, v168
    v_mfma_f32_16x16x32_bf16 v[148:151], a[212:215], a[100:103], v[148:151]
    ds_read_b128 a[200:203], v4 offset:61056
    v_exp_f32 v144, v144
    v_mfma_f32_16x16x32_bf16 v[156:159], a[212:215], a[116:119], v[156:159]
    ds_read_b128 a[204:207], v4 offset:61120
    v_add_f32 v13, v13, v169
    v_mfma_f32_16x16x32_bf16 v[148:151], a[216:219], a[104:107], v[148:151]
    ds_read_b128 a[208:211], v4 offset:65280
    v_add_f32 v13, v13, v170
    v_mfma_f32_16x16x32_bf16 v[156:159], a[216:219], a[120:123], v[156:159]
    s_waitcnt lgkmcnt(8)
    ds_read_b128 a[212:215], v4 offset:65344
    v_add_f32 v13, v13, v171
    v_mfma_f32_16x16x32_bf16 v[148:151], a[220:223], a[108:111], v[148:151]
    ds_read_b128 a[216:219], v4 offset:65408
    v_exp_f32 v145, v145
    v_mfma_f32_16x16x32_bf16 v[156:159], a[220:223], a[124:127], v[156:159]
    ds_read_b128 a[220:223], v4 offset:65472
    v_add_f32 v13, v13, v172
    v_mfma_f32_16x16x32_bf16 a[0:3], a[224:227], v[176:179], a[0:3]
    v_exp_f32 v146, v146
    v_mfma_f32_16x16x32_bf16 a[32:35], a[224:227], v[180:183], a[32:35]
    ds_read_b64_tr_b16 a[224:225], v5 offset:50688
    v_add_f32 v13, v13, v173
    v_mfma_f32_16x16x32_bf16 a[4:7], a[228:231], v[176:179], a[4:7]
    ds_read_b64_tr_b16 a[226:227], v5 offset:51200
    v_exp_f32 v147, v147
    v_mfma_f32_16x16x32_bf16 a[36:39], a[228:231], v[180:183], a[36:39]
    ds_read_b64_tr_b16 a[228:229], v5 offset:50720
    v_add_f32 v13, v13, v174
    v_mfma_f32_16x16x32_bf16 a[8:11], a[232:235], v[176:179], a[8:11]
    ds_read_b64_tr_b16 a[230:231], v5 offset:51232
    v_add_f32 v13, v13, v175
    v_mfma_f32_16x16x32_bf16 a[40:43], a[232:235], v[180:183], a[40:43]
    ds_read_b64_tr_b16 a[232:233], v5 offset:50752
    v_exp_f32 v148, v148
    v_mfma_f32_16x16x32_bf16 a[12:15], a[236:239], v[176:179], a[12:15]
    ds_read_b64_tr_b16 a[234:235], v5 offset:51264
    v_cvt_pk_bf16_f32 v184, v144, v145
    v_mfma_f32_16x16x32_bf16 a[44:47], a[236:239], v[180:183], a[44:47]
    ds_read_b64_tr_b16 a[236:237], v5 offset:50784
    v_cvt_pk_bf16_f32 v185, v146, v147
    v_mfma_f32_16x16x32_bf16 a[16:19], a[240:243], v[176:179], a[16:19]
    ds_read_b64_tr_b16 a[238:239], v5 offset:51296
    v_mov_b32 v14, v8
    v_mfma_f32_16x16x32_bf16 a[48:51], a[240:243], v[180:183], a[48:51]
    ds_read_b64_tr_b16 a[240:241], v5 offset:50816
    v_exp_f32 v149, v149
    v_mfma_f32_16x16x32_bf16 a[20:23], a[244:247], v[176:179], a[20:23]
    ds_read_b64_tr_b16 a[242:243], v5 offset:51328
    v_cvt_pk_bf16_f32 v186, v148, v149
    v_mfma_f32_16x16x32_bf16 a[52:55], a[244:247], v[180:183], a[52:55]
    s_waitcnt lgkmcnt(8)
    ds_read_b64_tr_b16 a[244:245], v5 offset:50848
    v_mov_b32 v2, v9
    v_mfma_f32_16x16x32_bf16 a[24:27], a[248:251], v[176:179], a[24:27]
    ds_read_b64_tr_b16 a[246:247], v5 offset:51360
    v_exp_f32 v150, v150
    v_mfma_f32_16x16x32_bf16 a[56:59], a[248:251], v[180:183], a[56:59]
    ds_read_b64_tr_b16 a[248:249], v5 offset:50880
    v_mfma_f32_16x16x32_bf16 a[28:31], a[252:255], v[176:179], a[28:31]
    ds_read_b64_tr_b16 a[250:251], v5 offset:51392
    v_mfma_f32_16x16x32_bf16 a[60:63], a[252:255], v[180:183], a[60:63]
    ds_read_b64_tr_b16 a[252:253], v5 offset:50912
    v_exp_f32 v151, v151
    v_mfma_f32_16x16x32_bf16 v[20:23], v[28:31], v[176:179], v[20:23]
    ds_read_b64_tr_b16 a[254:255], v5 offset:51424
    v_cvt_pk_bf16_f32 v187, v150, v151
    v_mfma_f32_16x16x32_bf16 v[24:27], v[28:31], v[180:183], v[24:27]
    v_exp_f32 v152, v152
    v_mfma_f32_16x16x32_bf16 v[160:163], a[192:195], a[96:99], v[200:203]
    v_exp_f32 v153, v153
    v_mfma_f32_16x16x32_bf16 v[168:171], a[192:195], a[112:115], v[204:207]
    v_exp_f32 v154, v154
    v_mfma_f32_16x16x32_bf16 v[160:163], a[196:199], a[100:103], v[160:163]
    v_exp_f32 v155, v155
    v_mfma_f32_16x16x32_bf16 v[168:171], a[196:199], a[116:119], v[168:171]
    v_exp_f32 v156, v156
    v_mfma_f32_16x16x32_bf16 v[160:163], a[200:203], a[104:107], v[160:163]
    v_exp_f32 v157, v157
    v_mfma_f32_16x16x32_bf16 v[168:171], a[200:203], a[120:123], v[168:171]
    v_exp_f32 v158, v158
    v_mfma_f32_16x16x32_bf16 v[160:163], a[204:207], a[108:111], v[160:163]
    v_exp_f32 v159, v159
    v_mfma_f32_16x16x32_bf16 v[168:171], a[204:207], a[124:127], v[168:171]
    v_cvt_pk_bf16_f32 v188, v152, v153
    v_cvt_pk_bf16_f32 v189, v154, v155
    v_mfma_f32_16x16x32_bf16 v[164:167], a[208:211], a[96:99], v[200:203]
    v_cvt_pk_bf16_f32 v190, v156, v157
    v_cvt_pk_bf16_f32 v191, v158, v159
    v_mfma_f32_16x16x32_bf16 v[172:175], a[208:211], a[112:115], v[204:207]
    v_permlane16_swap_b32 v8, v14
    v_mfma_f32_16x16x32_bf16 v[164:167], a[212:215], a[100:103], v[164:167]
    v_exp_f32 v160, v160
    v_mfma_f32_16x16x32_bf16 v[172:175], a[212:215], a[116:119], v[172:175]
    v_exp_f32 v161, v161
    v_mfma_f32_16x16x32_bf16 v[164:167], a[216:219], a[104:107], v[164:167]
    v_exp_f32 v162, v162
    v_mfma_f32_16x16x32_bf16 v[172:175], a[216:219], a[120:123], v[172:175]
    v_exp_f32 v163, v163
    v_mfma_f32_16x16x32_bf16 v[164:167], a[220:223], a[108:111], v[164:167]
    v_exp_f32 v168, v168
    v_mfma_f32_16x16x32_bf16 v[172:175], a[220:223], a[124:127], v[172:175]
    v_exp_f32 v169, v169
    v_mfma_f32_16x16x32_bf16 a[0:3], a[224:227], v[184:187], a[0:3]
    v_exp_f32 v170, v170
    v_mfma_f32_16x16x32_bf16 a[32:35], a[224:227], v[188:191], a[32:35]
    s_waitcnt lgkmcnt(8)
    ds_read_b64_tr_b16 a[224:225], v5 offset:59136
    v_add_f32 v8, v8, v14
    v_mfma_f32_16x16x32_bf16 a[4:7], a[228:231], v[184:187], a[4:7]
    ds_read_b64_tr_b16 a[226:227], v5 offset:59648
    v_cvt_pk_bf16_f32 v192, v160, v161
    v_mfma_f32_16x16x32_bf16 a[36:39], a[228:231], v[188:191], a[36:39]
    ds_read_b64_tr_b16 a[228:229], v5 offset:59168
    v_exp_f32 v164, v164
    v_mfma_f32_16x16x32_bf16 a[8:11], a[232:235], v[184:187], a[8:11]
    ds_read_b64_tr_b16 a[230:231], v5 offset:59680
    v_cvt_pk_bf16_f32 v193, v162, v163
    v_mfma_f32_16x16x32_bf16 a[40:43], a[232:235], v[188:191], a[40:43]
    ds_read_b64_tr_b16 a[232:233], v5 offset:59200
    v_mov_b32 v14, v8
    v_mfma_f32_16x16x32_bf16 a[12:15], a[236:239], v[184:187], a[12:15]
    ds_read_b64_tr_b16 a[234:235], v5 offset:59712
    v_exp_f32 v165, v165
    v_mfma_f32_16x16x32_bf16 a[44:47], a[236:239], v[188:191], a[44:47]
    s_waitcnt lgkmcnt(8)
    ds_read_b64_tr_b16 a[236:237], v5 offset:59232
    v_cvt_pk_bf16_f32 v194, v164, v165
    v_mfma_f32_16x16x32_bf16 a[16:19], a[240:243], v[184:187], a[16:19]
    ds_read_b64_tr_b16 a[238:239], v5 offset:59744
    v_cvt_pk_bf16_f32 v196, v168, v169
    v_mfma_f32_16x16x32_bf16 a[48:51], a[240:243], v[188:191], a[48:51]
    ds_read_b64_tr_b16 a[240:241], v5 offset:59264
    v_exp_f32 v166, v166
    v_mfma_f32_16x16x32_bf16 a[20:23], a[244:247], v[184:187], a[20:23]
    ds_read_b64_tr_b16 a[242:243], v5 offset:59776
    v_mfma_f32_16x16x32_bf16 a[52:55], a[244:247], v[188:191], a[52:55]
    ds_read_b64_tr_b16 a[244:245], v5 offset:59296
    v_mfma_f32_16x16x32_bf16 a[24:27], a[248:251], v[184:187], a[24:27]
    ds_read_b64_tr_b16 a[246:247], v5 offset:59808
    v_mfma_f32_16x16x32_bf16 a[56:59], a[248:251], v[188:191], a[56:59]
    s_waitcnt lgkmcnt(8)
    ds_read_b64_tr_b16 a[248:249], v5 offset:59328
    v_exp_f32 v167, v167
    v_mfma_f32_16x16x32_bf16 a[28:31], a[252:255], v[184:187], a[28:31]
    ds_read_b64_tr_b16 a[250:251], v5 offset:59840
    v_cvt_pk_bf16_f32 v195, v166, v167
    v_mfma_f32_16x16x32_bf16 a[60:63], a[252:255], v[188:191], a[60:63]
    ds_read_b64_tr_b16 a[252:253], v5 offset:59360
    v_mfma_f32_16x16x32_bf16 v[20:23], v[28:31], v[184:187], v[20:23]
    ds_read_b64_tr_b16 a[254:255], v5 offset:59872
    v_exp_f32 v171, v171
    v_mfma_f32_16x16x32_bf16 v[24:27], v[28:31], v[188:191], v[24:27]
    v_exp_f32 v172, v172
    v_mfma_f32_16x16x32_bf16 v[128:131], a[192:195], a[128:131], v[208:211]
    v_exp_f32 v173, v173
    v_mfma_f32_16x16x32_bf16 v[136:139], a[192:195], a[144:147], v[212:215]
    ds_read_b128 a[192:195], v4 offset:52224
    v_cvt_pk_bf16_f32 v197, v170, v171
    v_mfma_f32_16x16x32_bf16 v[128:131], a[196:199], a[132:135], v[128:131]
    v_exp_f32 v174, v174
    v_mfma_f32_16x16x32_bf16 v[136:139], a[196:199], a[148:151], v[136:139]
    ds_read_b128 a[196:199], v4 offset:52288
    v_cvt_pk_bf16_f32 v198, v172, v173
    v_mfma_f32_16x16x32_bf16 v[128:131], a[200:203], a[136:139], v[128:131]
    v_exp_f32 v175, v175
    v_mfma_f32_16x16x32_bf16 v[136:139], a[200:203], a[152:155], v[136:139]
    ds_read_b128 a[200:203], v4 offset:52352
    v_permlane32_swap_b32 v8, v14
    v_mfma_f32_16x16x32_bf16 v[128:131], a[204:207], a[140:143], v[128:131]
    v_add_f32 v8, v8, v14
    v_cvt_pk_bf16_f32 v199, v174, v175
    v_mfma_f32_16x16x32_bf16 v[136:139], a[204:207], a[156:159], v[136:139]
    ds_read_b128 a[204:207], v4 offset:52416
    v_mfma_f32_16x16x32_bf16 v[132:135], a[208:211], a[128:131], v[208:211]
    v_permlane16_swap_b32 v9, v2
    v_mfma_f32_16x16x32_bf16 v[140:143], a[208:211], a[144:147], v[212:215]
    ds_read_b128 a[208:211], v4 offset:56576
    v_add_f32 v9, v9, v2
    v_mfma_f32_16x16x32_bf16 v[132:135], a[212:215], a[132:135], v[132:135]
    v_exp_f32 v128, v128
    v_mfma_f32_16x16x32_bf16 v[140:143], a[212:215], a[148:151], v[140:143]
    ds_read_b128 a[212:215], v4 offset:56640
    v_mov_b32 v2, v9
    v_mfma_f32_16x16x32_bf16 v[132:135], a[216:219], a[136:139], v[132:135]
    v_exp_f32 v129, v129
    v_mfma_f32_16x16x32_bf16 v[140:143], a[216:219], a[152:155], v[140:143]
    ds_read_b128 a[216:219], v4 offset:56704
    v_exp_f32 v130, v130
    v_mfma_f32_16x16x32_bf16 v[132:135], a[220:223], a[140:143], v[132:135]
    v_exp_f32 v131, v131
    v_mfma_f32_16x16x32_bf16 v[140:143], a[220:223], a[156:159], v[140:143]
    ds_read_b128 a[220:223], v4 offset:56768
    v_cvt_pk_bf16_f32 v176, v128, v129
    v_mfma_f32_16x16x32_bf16 v[20:23], v[28:31], v[192:195], v[20:23]
    v_exp_f32 v136, v136
    v_mfma_f32_16x16x32_bf16 a[0:3], a[224:227], v[192:195], a[0:3]
    v_exp_f32 v137, v137
    v_mfma_f32_16x16x32_bf16 a[4:7], a[228:231], v[192:195], a[4:7]
    s_waitcnt lgkmcnt(8)
    v_exp_f32 v132, v132
    v_mfma_f32_16x16x32_bf16 a[8:11], a[232:235], v[192:195], a[8:11]
    v_exp_f32 v133, v133
    v_mfma_f32_16x16x32_bf16 a[12:15], a[236:239], v[192:195], a[12:15]
    v_exp_f32 v134, v134
    v_mfma_f32_16x16x32_bf16 a[16:19], a[240:243], v[192:195], a[16:19]
    v_exp_f32 v135, v135
    v_mfma_f32_16x16x32_bf16 a[20:23], a[244:247], v[192:195], a[20:23]
    v_exp_f32 v138, v138
    v_mfma_f32_16x16x32_bf16 a[24:27], a[248:251], v[192:195], a[24:27]
    v_add_f32 v8, v8, v20
    v_cvt_pk_bf16_f32 v177, v130, v131
    v_mfma_f32_16x16x32_bf16 a[28:31], a[252:255], v[192:195], a[28:31]
    v_rcp_f32 v8, v8
    v_mfma_f32_16x16x32_bf16 v[24:27], v[28:31], v[196:199], v[24:27]
    v_exp_f32 v139, v139
    v_mfma_f32_16x16x32_bf16 a[32:35], a[224:227], v[196:199], a[32:35]
    v_permlane32_swap_b32 v9, v2
    v_mfma_f32_16x16x32_bf16 a[36:39], a[228:231], v[196:199], a[36:39]
    v_exp_f32 v140, v140
    v_mfma_f32_16x16x32_bf16 a[40:43], a[232:235], v[196:199], a[40:43]
    v_add_f32 v9, v9, v2
    v_cvt_pk_bf16_f32 v178, v132, v133
    v_mfma_f32_16x16x32_bf16 a[44:47], a[236:239], v[196:199], a[44:47]
    v_exp_f32 v141, v141
    v_add_u32 v6, 0, v17
    v_accvgpr_read_b32 v224, a0
    v_accvgpr_read_b32 v225, a1
    v_accvgpr_read_b32 v226, a2
    v_accvgpr_read_b32 v227, a3
    v_accvgpr_read_b32 v228, a4
    v_accvgpr_read_b32 v229, a5
    v_accvgpr_read_b32 v230, a6
    v_accvgpr_read_b32 v231, a7
    v_pk_mul_f32 v[224:225], v[224:225], v[8:9] op_sel:[0,0] op_sel_hi:[1,0]
    v_pk_mul_f32 v[226:227], v[226:227], v[8:9] op_sel:[0,0] op_sel_hi:[1,0]
    v_pk_mul_f32 v[228:229], v[228:229], v[8:9] op_sel:[0,0] op_sel_hi:[1,0]
    v_pk_mul_f32 v[230:231], v[230:231], v[8:9] op_sel:[0,0] op_sel_hi:[1,0]
    v_cvt_pk_bf16_f32 v232, v224, v225
    v_cvt_pk_bf16_f32 v233, v226, v227
    v_cvt_pk_bf16_f32 v234, v228, v229
    v_cvt_pk_bf16_f32 v235, v230, v231
    v_mfma_f32_16x16x32_bf16 a[48:51], a[240:243], v[196:199], a[48:51]
    ds_write_b64 v15, v[232:233] offset:0
    ds_write_b64 v15, v[234:235] offset:32
    v_exp_f32 v142, v142
    v_accvgpr_read_b32 v224, a8
    v_accvgpr_read_b32 v225, a9
    v_accvgpr_read_b32 v226, a10
    v_accvgpr_read_b32 v227, a11
    v_accvgpr_read_b32 v228, a12
    v_accvgpr_read_b32 v229, a13
    v_accvgpr_read_b32 v230, a14
    v_accvgpr_read_b32 v231, a15
    v_pk_mul_f32 v[224:225], v[224:225], v[8:9] op_sel:[0,0] op_sel_hi:[1,0]
    v_pk_mul_f32 v[226:227], v[226:227], v[8:9] op_sel:[0,0] op_sel_hi:[1,0]
    v_pk_mul_f32 v[228:229], v[228:229], v[8:9] op_sel:[0,0] op_sel_hi:[1,0]
    v_pk_mul_f32 v[230:231], v[230:231], v[8:9] op_sel:[0,0] op_sel_hi:[1,0]
    v_cvt_pk_bf16_f32 v236, v224, v225
    v_cvt_pk_bf16_f32 v237, v226, v227
    v_cvt_pk_bf16_f32 v238, v228, v229
    v_cvt_pk_bf16_f32 v239, v230, v231
    v_mfma_f32_16x16x32_bf16 a[52:55], a[244:247], v[196:199], a[52:55]
    ds_write_b64 v15, v[236:237] offset:64
    ds_write_b64 v15, v[238:239] offset:96
    v_exp_f32 v143, v143
    v_accvgpr_read_b32 v224, a16
    v_accvgpr_read_b32 v225, a17
    v_accvgpr_read_b32 v226, a18
    v_accvgpr_read_b32 v227, a19
    v_accvgpr_read_b32 v228, a20
    v_accvgpr_read_b32 v229, a21
    v_accvgpr_read_b32 v230, a22
    v_accvgpr_read_b32 v231, a23
    v_pk_mul_f32 v[224:225], v[224:225], v[8:9] op_sel:[0,0] op_sel_hi:[1,0]
    v_pk_mul_f32 v[226:227], v[226:227], v[8:9] op_sel:[0,0] op_sel_hi:[1,0]
    v_pk_mul_f32 v[228:229], v[228:229], v[8:9] op_sel:[0,0] op_sel_hi:[1,0]
    v_pk_mul_f32 v[230:231], v[230:231], v[8:9] op_sel:[0,0] op_sel_hi:[1,0]
    v_cvt_pk_bf16_f32 v232, v224, v225
    v_cvt_pk_bf16_f32 v233, v226, v227
    v_cvt_pk_bf16_f32 v234, v228, v229
    v_cvt_pk_bf16_f32 v235, v230, v231
    v_mfma_f32_16x16x32_bf16 a[56:59], a[248:251], v[196:199], a[56:59]
    ds_write_b64 v15, v[232:233] offset:128
    ds_write_b64 v15, v[234:235] offset:160
    v_add_f32 v9, v9, v24
    v_cvt_pk_bf16_f32 v179, v134, v135
    v_accvgpr_read_b32 v224, a24
    v_accvgpr_read_b32 v225, a25
    v_accvgpr_read_b32 v226, a26
    v_accvgpr_read_b32 v227, a27
    v_accvgpr_read_b32 v228, a28
    v_accvgpr_read_b32 v229, a29
    v_accvgpr_read_b32 v230, a30
    v_accvgpr_read_b32 v231, a31
    v_pk_mul_f32 v[224:225], v[224:225], v[8:9] op_sel:[0,0] op_sel_hi:[1,0]
    v_pk_mul_f32 v[226:227], v[226:227], v[8:9] op_sel:[0,0] op_sel_hi:[1,0]
    v_pk_mul_f32 v[228:229], v[228:229], v[8:9] op_sel:[0,0] op_sel_hi:[1,0]
    v_pk_mul_f32 v[230:231], v[230:231], v[8:9] op_sel:[0,0] op_sel_hi:[1,0]
    v_cvt_pk_bf16_f32 v236, v224, v225
    v_cvt_pk_bf16_f32 v237, v226, v227
    v_cvt_pk_bf16_f32 v238, v228, v229
    v_cvt_pk_bf16_f32 v239, v230, v231
    v_mfma_f32_16x16x32_bf16 a[60:63], a[252:255], v[196:199], a[60:63]
    s_waitcnt lgkmcnt(8)
    ds_write_b64 v15, v[236:237] offset:192
    ds_write_b64 v15, v[238:239] offset:224
    ds_read_b128 v[240:243], v16 offset:0
    ds_read_b128 v[244:247], v16 offset:1088
    ds_read_b128 v[248:251], v16 offset:2176
    ds_read_b128 v[252:255], v16 offset:3264
    v_rcp_f32 v9, v9
    v_mfma_f32_16x16x32_bf16 v[144:147], a[192:195], a[128:131], v[208:211]
    v_cvt_pk_bf16_f32 v180, v136, v137
    v_cvt_pk_bf16_f32 v181, v138, v139
    v_mfma_f32_16x16x32_bf16 v[152:155], a[192:195], a[144:147], v[212:215]
    ds_read_b128 a[192:195], v4 offset:43520
    v_cvt_pk_bf16_f32 v182, v140, v141
    v_mfma_f32_16x16x32_bf16 v[144:147], a[196:199], a[132:135], v[144:147]
    ds_read_b64_tr_b16 a[0:1], v5 offset:50688
    v_cvt_pk_bf16_f32 v183, v142, v143
    v_mfma_f32_16x16x32_bf16 v[152:155], a[196:199], a[148:151], v[152:155]
    ds_read_b128 a[196:199], v4 offset:43584
    v_mfma_f32_16x16x32_bf16 v[144:147], a[200:203], a[136:139], v[144:147]
    ds_read_b64_tr_b16 a[2:3], v5 offset:51200
    s_waitcnt lgkmcnt(7)
    buffer_store_dwordx4 v[240:243], v6, s[28:31], 0 offen offset:0 sc0 sc1
    v_add_u32 v7, 4096, v17
    v_accvgpr_read_b32 v224, a32
    v_accvgpr_read_b32 v225, a33
    v_accvgpr_read_b32 v226, a34
    v_accvgpr_read_b32 v227, a35
    v_accvgpr_read_b32 v228, a36
    v_accvgpr_read_b32 v229, a37
    v_accvgpr_read_b32 v230, a38
    v_accvgpr_read_b32 v231, a39
    v_pk_mul_f32 v[224:225], v[224:225], v[8:9] op_sel:[0,1] op_sel_hi:[1,1]
    v_pk_mul_f32 v[226:227], v[226:227], v[8:9] op_sel:[0,1] op_sel_hi:[1,1]
    v_pk_mul_f32 v[228:229], v[228:229], v[8:9] op_sel:[0,1] op_sel_hi:[1,1]
    v_pk_mul_f32 v[230:231], v[230:231], v[8:9] op_sel:[0,1] op_sel_hi:[1,1]
    v_cvt_pk_bf16_f32 v232, v224, v225
    v_cvt_pk_bf16_f32 v233, v226, v227
    v_cvt_pk_bf16_f32 v234, v228, v229
    v_cvt_pk_bf16_f32 v235, v230, v231
    v_mfma_f32_16x16x32_bf16 v[152:155], a[200:203], a[152:155], v[152:155]
    ds_read_b128 a[200:203], v4 offset:43648
    ds_write_b64 v15, v[232:233] offset:0
    ds_write_b64 v15, v[234:235] offset:32
    v_accvgpr_read_b32 v224, a40
    v_accvgpr_read_b32 v225, a41
    v_accvgpr_read_b32 v226, a42
    v_accvgpr_read_b32 v227, a43
    v_accvgpr_read_b32 v228, a44
    v_accvgpr_read_b32 v229, a45
    v_accvgpr_read_b32 v230, a46
    v_accvgpr_read_b32 v231, a47
    v_pk_mul_f32 v[224:225], v[224:225], v[8:9] op_sel:[0,1] op_sel_hi:[1,1]
    v_pk_mul_f32 v[226:227], v[226:227], v[8:9] op_sel:[0,1] op_sel_hi:[1,1]
    v_pk_mul_f32 v[228:229], v[228:229], v[8:9] op_sel:[0,1] op_sel_hi:[1,1]
    v_pk_mul_f32 v[230:231], v[230:231], v[8:9] op_sel:[0,1] op_sel_hi:[1,1]
    v_cvt_pk_bf16_f32 v236, v224, v225
    v_cvt_pk_bf16_f32 v237, v226, v227
    v_cvt_pk_bf16_f32 v238, v228, v229
    v_cvt_pk_bf16_f32 v239, v230, v231
    v_mfma_f32_16x16x32_bf16 v[144:147], a[204:207], a[140:143], v[144:147]
    ds_read_b64_tr_b16 a[4:5], v5 offset:50720
    s_waitcnt lgkmcnt(8)
    buffer_store_dwordx4 v[244:247], v6, s[28:31], 0 offen offset:1024 sc0 sc1
    ds_write_b64 v15, v[236:237] offset:64
    ds_write_b64 v15, v[238:239] offset:96
    v_accvgpr_read_b32 v224, a48
    v_accvgpr_read_b32 v225, a49
    v_accvgpr_read_b32 v226, a50
    v_accvgpr_read_b32 v227, a51
    v_accvgpr_read_b32 v228, a52
    v_accvgpr_read_b32 v229, a53
    v_accvgpr_read_b32 v230, a54
    v_accvgpr_read_b32 v231, a55
    v_pk_mul_f32 v[224:225], v[224:225], v[8:9] op_sel:[0,1] op_sel_hi:[1,1]
    v_pk_mul_f32 v[226:227], v[226:227], v[8:9] op_sel:[0,1] op_sel_hi:[1,1]
    v_pk_mul_f32 v[228:229], v[228:229], v[8:9] op_sel:[0,1] op_sel_hi:[1,1]
    v_pk_mul_f32 v[230:231], v[230:231], v[8:9] op_sel:[0,1] op_sel_hi:[1,1]
    v_cvt_pk_bf16_f32 v232, v224, v225
    v_cvt_pk_bf16_f32 v233, v226, v227
    v_cvt_pk_bf16_f32 v234, v228, v229
    v_cvt_pk_bf16_f32 v235, v230, v231
    v_mfma_f32_16x16x32_bf16 v[152:155], a[204:207], a[156:159], v[152:155]
    ds_read_b128 a[204:207], v4 offset:43712
    ds_write_b64 v15, v[232:233] offset:128
    ds_write_b64 v15, v[234:235] offset:160
    v_accvgpr_read_b32 v224, a56
    v_accvgpr_read_b32 v225, a57
    v_accvgpr_read_b32 v226, a58
    v_accvgpr_read_b32 v227, a59
    v_accvgpr_read_b32 v228, a60
    v_accvgpr_read_b32 v229, a61
    v_accvgpr_read_b32 v230, a62
    v_accvgpr_read_b32 v231, a63
    v_pk_mul_f32 v[224:225], v[224:225], v[8:9] op_sel:[0,1] op_sel_hi:[1,1]
    v_pk_mul_f32 v[226:227], v[226:227], v[8:9] op_sel:[0,1] op_sel_hi:[1,1]
    v_pk_mul_f32 v[228:229], v[228:229], v[8:9] op_sel:[0,1] op_sel_hi:[1,1]
    v_pk_mul_f32 v[230:231], v[230:231], v[8:9] op_sel:[0,1] op_sel_hi:[1,1]
    v_cvt_pk_bf16_f32 v236, v224, v225
    v_cvt_pk_bf16_f32 v237, v226, v227
    v_cvt_pk_bf16_f32 v238, v228, v229
    v_cvt_pk_bf16_f32 v239, v230, v231
    v_mfma_f32_16x16x32_bf16 v[148:151], a[208:211], a[128:131], v[208:211]
    ds_read_b64_tr_b16 a[6:7], v5 offset:51232
    buffer_store_dwordx4 v[248:251], v6, s[28:31], 0 offen offset:2048 sc0 sc1
    v_mfma_f32_16x16x32_bf16 v[156:159], a[208:211], a[144:147], v[212:215]
    ds_read_b128 a[208:211], v4 offset:47872
    v_mfma_f32_16x16x32_bf16 v[148:151], a[212:215], a[132:135], v[148:151]
    ds_read_b64_tr_b16 a[8:9], v5 offset:50752
    buffer_store_dwordx4 v[252:255], v6, s[28:31], 0 offen offset:3072 sc0 sc1
    ds_write_b64 v15, v[236:237] offset:192
    ds_write_b64 v15, v[238:239] offset:224
    ds_read_b128 v[240:243], v16 offset:0
    ds_read_b128 v[244:247], v16 offset:1088
    ds_read_b128 v[248:251], v16 offset:2176
    ds_read_b128 v[252:255], v16 offset:3264
    v_mfma_f32_16x16x32_bf16 v[156:159], a[212:215], a[148:151], v[156:159]
    ds_read_b128 a[212:215], v4 offset:47936
    v_mfma_f32_16x16x32_bf16 v[148:151], a[216:219], a[136:139], v[148:151]
    ds_read_b64_tr_b16 a[10:11], v5 offset:51264
    v_exp_f32 v144, v144
    v_mfma_f32_16x16x32_bf16 v[156:159], a[216:219], a[152:155], v[156:159]
    ds_read_b128 a[216:219], v4 offset:48000
    v_mfma_f32_16x16x32_bf16 v[148:151], a[220:223], a[140:143], v[148:151]
    ds_read_b64_tr_b16 a[12:13], v5 offset:50784
    v_mfma_f32_16x16x32_bf16 v[156:159], a[220:223], a[156:159], v[156:159]
    ds_read_b128 a[220:223], v4 offset:48064
    s_waitcnt lgkmcnt(8)
    buffer_store_dwordx4 v[240:243], v7, s[28:31], 0 offen offset:0 sc0 sc1
    v_exp_f32 v145, v145
    v_mfma_f32_16x16x32_bf16 a[64:67], a[224:227], v[176:179], a[64:67]
    ds_read_b64_tr_b16 a[14:15], v5 offset:51296
    v_cvt_pk_bf16_f32 v184, v144, v145
    v_mfma_f32_16x16x32_bf16 v[32:35], a[224:227], v[180:183], v[32:35]
    ds_read_b64_tr_b16 a[16:17], v5 offset:50816
    s_waitcnt lgkmcnt(8)
    buffer_store_dwordx4 v[244:247], v7, s[28:31], 0 offen offset:1024 sc0 sc1
    v_mov_b32 v14, v10
    v_mfma_f32_16x16x32_bf16 a[68:71], a[228:231], v[176:179], a[68:71]
    ds_read_b64_tr_b16 a[18:19], v5 offset:51328
    v_mov_b32 v2, v11
    v_mfma_f32_16x16x32_bf16 v[36:39], a[228:231], v[180:183], v[36:39]
    ds_read_b64_tr_b16 a[20:21], v5 offset:50848
    buffer_store_dwordx4 v[248:251], v7, s[28:31], 0 offen offset:2048 sc0 sc1
    v_exp_f32 v146, v146
    v_mfma_f32_16x16x32_bf16 a[72:75], a[232:235], v[176:179], a[72:75]
    ds_read_b64_tr_b16 a[22:23], v5 offset:51360
    v_mfma_f32_16x16x32_bf16 v[40:43], a[232:235], v[180:183], v[40:43]
    ds_read_b64_tr_b16 a[24:25], v5 offset:50880
    s_waitcnt lgkmcnt(8)
    buffer_store_dwordx4 v[252:255], v7, s[28:31], 0 offen offset:3072 sc0 sc1
    v_mfma_f32_16x16x32_bf16 a[76:79], a[236:239], v[176:179], a[76:79]
    ds_read_b64_tr_b16 a[26:27], v5 offset:51392
    v_exp_f32 v147, v147
    v_mfma_f32_16x16x32_bf16 v[44:47], a[236:239], v[180:183], v[44:47]
    ds_read_b64_tr_b16 a[28:29], v5 offset:50912
    v_cvt_pk_bf16_f32 v185, v146, v147
    v_mfma_f32_16x16x32_bf16 a[80:83], a[240:243], v[176:179], a[80:83]
    ds_read_b64_tr_b16 a[30:31], v5 offset:51424
    v_mfma_f32_16x16x32_bf16 v[48:51], a[240:243], v[180:183], v[48:51]
    ds_read_b64_tr_b16 a[32:33], v5 offset:42240
    v_exp_f32 v148, v148
    v_mfma_f32_16x16x32_bf16 a[84:87], a[244:247], v[176:179], a[84:87]
    ds_read_b64_tr_b16 a[34:35], v5 offset:42752
    v_mfma_f32_16x16x32_bf16 v[52:55], a[244:247], v[180:183], v[52:55]
    ds_read_b64_tr_b16 a[36:37], v5 offset:42272
    v_mfma_f32_16x16x32_bf16 a[88:91], a[248:251], v[176:179], a[88:91]
    ds_read_b64_tr_b16 a[38:39], v5 offset:42784
    v_mfma_f32_16x16x32_bf16 v[56:59], a[248:251], v[180:183], v[56:59]
    ds_read_b64_tr_b16 a[40:41], v5 offset:42304
    v_exp_f32 v149, v149
    v_mfma_f32_16x16x32_bf16 a[92:95], a[252:255], v[176:179], a[92:95]
    ds_read_b64_tr_b16 a[42:43], v5 offset:42816
    v_cvt_pk_bf16_f32 v186, v148, v149
    v_mfma_f32_16x16x32_bf16 v[60:63], a[252:255], v[180:183], v[60:63]
    ds_read_b64_tr_b16 a[44:45], v5 offset:42336
    v_mfma_f32_16x16x32_bf16 v[20:23], v[28:31], v[176:179], 0
    ds_read_b64_tr_b16 a[46:47], v5 offset:42848
    v_exp_f32 v150, v150
    v_mfma_f32_16x16x32_bf16 v[24:27], v[28:31], v[180:183], 0
    ds_read_b64_tr_b16 a[48:49], v5 offset:42368
    v_mfma_f32_16x16x32_bf16 v[160:163], a[192:195], a[128:131], v[208:211]
    ds_read_b64_tr_b16 a[50:51], v5 offset:42880
    v_mfma_f32_16x16x32_bf16 v[168:171], a[192:195], a[144:147], v[212:215]
    ds_read_b64_tr_b16 a[52:53], v5 offset:42400
    v_exp_f32 v151, v151
    v_mfma_f32_16x16x32_bf16 v[160:163], a[196:199], a[132:135], v[160:163]
    ds_read_b64_tr_b16 a[54:55], v5 offset:42912
    v_cvt_pk_bf16_f32 v187, v150, v151
    v_mfma_f32_16x16x32_bf16 v[168:171], a[196:199], a[148:151], v[168:171]
    ds_read_b64_tr_b16 a[56:57], v5 offset:42432
    v_mfma_f32_16x16x32_bf16 v[160:163], a[200:203], a[136:139], v[160:163]
    ds_read_b64_tr_b16 a[58:59], v5 offset:42944
    v_mfma_f32_16x16x32_bf16 v[168:171], a[200:203], a[152:155], v[168:171]
    ds_read_b64_tr_b16 a[60:61], v5 offset:42464
    v_exp_f32 v152, v152
    v_mfma_f32_16x16x32_bf16 v[160:163], a[204:207], a[140:143], v[160:163]
    ds_read_b64_tr_b16 a[62:63], v5 offset:42976
    v_mfma_f32_16x16x32_bf16 v[168:171], a[204:207], a[156:159], v[168:171]
    v_exp_f32 v153, v153
    v_mfma_f32_16x16x32_bf16 v[164:167], a[208:211], a[128:131], v[208:211]
    v_exp_f32 v154, v154
    v_mfma_f32_16x16x32_bf16 v[172:175], a[208:211], a[144:147], v[212:215]
    v_exp_f32 v155, v155
    v_mfma_f32_16x16x32_bf16 v[164:167], a[212:215], a[132:135], v[164:167]
    v_exp_f32 v156, v156
    v_mfma_f32_16x16x32_bf16 v[172:175], a[212:215], a[148:151], v[172:175]
    v_exp_f32 v157, v157
    v_mfma_f32_16x16x32_bf16 v[164:167], a[216:219], a[136:139], v[164:167]
    v_exp_f32 v158, v158
    v_mfma_f32_16x16x32_bf16 v[172:175], a[216:219], a[152:155], v[172:175]
    s_waitcnt lgkmcnt(8)
    v_exp_f32 v159, v159
    v_mfma_f32_16x16x32_bf16 v[164:167], a[220:223], a[140:143], v[164:167]
    v_cvt_pk_bf16_f32 v188, v152, v153
    v_cvt_pk_bf16_f32 v189, v154, v155
    v_mfma_f32_16x16x32_bf16 v[172:175], a[220:223], a[156:159], v[172:175]
    v_cvt_pk_bf16_f32 v190, v156, v157
    v_cvt_pk_bf16_f32 v191, v158, v159
    v_mfma_f32_16x16x32_bf16 a[64:67], a[0:3], v[184:187], a[64:67]
    v_exp_f32 v160, v160
    v_mfma_f32_16x16x32_bf16 v[32:35], a[0:3], v[188:191], v[32:35]
    v_exp_f32 v161, v161
    v_mfma_f32_16x16x32_bf16 a[68:71], a[4:7], v[184:187], a[68:71]
    v_exp_f32 v162, v162
    v_mfma_f32_16x16x32_bf16 v[36:39], a[4:7], v[188:191], v[36:39]
    v_exp_f32 v163, v163
    v_mfma_f32_16x16x32_bf16 a[72:75], a[8:11], v[184:187], a[72:75]
    v_exp_f32 v164, v164
    v_mfma_f32_16x16x32_bf16 v[40:43], a[8:11], v[188:191], v[40:43]
    v_exp_f32 v165, v165
    v_mfma_f32_16x16x32_bf16 a[76:79], a[12:15], v[184:187], a[76:79]
    v_exp_f32 v166, v166
    v_mfma_f32_16x16x32_bf16 v[44:47], a[12:15], v[188:191], v[44:47]
    v_exp_f32 v167, v167
    v_mfma_f32_16x16x32_bf16 a[80:83], a[16:19], v[184:187], a[80:83]
    v_exp_f32 v168, v168
    v_mfma_f32_16x16x32_bf16 v[48:51], a[16:19], v[188:191], v[48:51]
    v_exp_f32 v169, v169
    v_mfma_f32_16x16x32_bf16 a[84:87], a[20:23], v[184:187], a[84:87]
    v_exp_f32 v170, v170
    v_mfma_f32_16x16x32_bf16 v[52:55], a[20:23], v[188:191], v[52:55]
    v_exp_f32 v171, v171
    v_mfma_f32_16x16x32_bf16 a[88:91], a[24:27], v[184:187], a[88:91]
    v_exp_f32 v172, v172
    v_mfma_f32_16x16x32_bf16 v[56:59], a[24:27], v[188:191], v[56:59]
    v_exp_f32 v173, v173
    v_mfma_f32_16x16x32_bf16 a[92:95], a[28:31], v[184:187], a[92:95]
    v_exp_f32 v174, v174
    v_mfma_f32_16x16x32_bf16 v[60:63], a[28:31], v[188:191], v[60:63]
    v_exp_f32 v175, v175
    v_mfma_f32_16x16x32_bf16 v[20:23], v[28:31], v[184:187], v[20:23]
    v_permlane16_swap_b32 v10, v14
    v_mfma_f32_16x16x32_bf16 v[24:27], v[28:31], v[188:191], v[24:27]
    v_cvt_pk_bf16_f32 v192, v160, v161
    v_add_f32 v10, v10, v14
    v_mfma_f32_16x16x32_bf16 v[128:131], a[192:195], a[160:163], v[216:219]
    v_cvt_pk_bf16_f32 v193, v162, v163
    v_cvt_pk_bf16_f32 v194, v164, v165
    v_mfma_f32_16x16x32_bf16 v[136:139], a[192:195], a[176:179], v[220:223]
    ds_read_b128 a[192:195], v4 offset:52224
    v_cvt_pk_bf16_f32 v195, v166, v167
    v_mfma_f32_16x16x32_bf16 v[128:131], a[196:199], a[164:167], v[128:131]
    v_mov_b32 v14, v10
    v_cvt_pk_bf16_f32 v196, v168, v169
    v_mfma_f32_16x16x32_bf16 v[136:139], a[196:199], a[180:183], v[136:139]
    ds_read_b128 a[196:199], v4 offset:52288
    v_permlane32_swap_b32 v10, v14
    v_mfma_f32_16x16x32_bf16 v[128:131], a[200:203], a[168:171], v[128:131]
    v_add_f32 v10, v10, v14
    v_cvt_pk_bf16_f32 v197, v170, v171
    v_mfma_f32_16x16x32_bf16 v[136:139], a[200:203], a[184:187], v[136:139]
    ds_read_b128 a[200:203], v4 offset:52352
    v_cvt_pk_bf16_f32 v198, v172, v173
    v_mfma_f32_16x16x32_bf16 v[128:131], a[204:207], a[172:175], v[128:131]
    v_permlane16_swap_b32 v11, v2
    v_mfma_f32_16x16x32_bf16 v[136:139], a[204:207], a[188:191], v[136:139]
    ds_read_b128 a[204:207], v4 offset:52416
    v_add_f32 v11, v11, v2
    v_mfma_f32_16x16x32_bf16 v[132:135], a[208:211], a[160:163], v[216:219]
    v_cvt_pk_bf16_f32 v199, v174, v175
    v_mov_b32 v2, v11
    v_mfma_f32_16x16x32_bf16 v[140:143], a[208:211], a[176:179], v[220:223]
    ds_read_b128 a[208:211], v4 offset:56576
    v_permlane32_swap_b32 v11, v2
    v_mfma_f32_16x16x32_bf16 v[132:135], a[212:215], a[164:167], v[132:135]
    v_exp_f32 v128, v128
    v_mfma_f32_16x16x32_bf16 v[140:143], a[212:215], a[180:183], v[140:143]
    ds_read_b128 a[212:215], v4 offset:56640
    v_add_f32 v11, v11, v2
    v_mfma_f32_16x16x32_bf16 v[132:135], a[216:219], a[168:171], v[132:135]
    v_exp_f32 v129, v129
    v_mfma_f32_16x16x32_bf16 v[140:143], a[216:219], a[184:187], v[140:143]
    ds_read_b128 a[216:219], v4 offset:56704
    v_cvt_pk_bf16_f32 v176, v128, v129
    v_mfma_f32_16x16x32_bf16 v[132:135], a[220:223], a[172:175], v[132:135]
    v_exp_f32 v130, v130
    v_mfma_f32_16x16x32_bf16 v[140:143], a[220:223], a[188:191], v[140:143]
    ds_read_b128 a[220:223], v4 offset:56768
    v_mfma_f32_16x16x32_bf16 v[20:23], v[28:31], v[192:195], v[20:23]
    v_exp_f32 v131, v131
    v_mfma_f32_16x16x32_bf16 a[64:67], a[32:35], v[192:195], a[64:67]
    v_exp_f32 v136, v136
    v_mfma_f32_16x16x32_bf16 a[68:71], a[36:39], v[192:195], a[68:71]
    v_exp_f32 v132, v132
    v_mfma_f32_16x16x32_bf16 a[72:75], a[40:43], v[192:195], a[72:75]
    v_exp_f32 v133, v133
    v_mfma_f32_16x16x32_bf16 a[76:79], a[44:47], v[192:195], a[76:79]
    s_waitcnt lgkmcnt(8)
    v_exp_f32 v134, v134
    v_mfma_f32_16x16x32_bf16 a[80:83], a[48:51], v[192:195], a[80:83]
    v_exp_f32 v135, v135
    v_mfma_f32_16x16x32_bf16 a[84:87], a[52:55], v[192:195], a[84:87]
    v_exp_f32 v137, v137
    v_mfma_f32_16x16x32_bf16 a[88:91], a[56:59], v[192:195], a[88:91]
    v_add_f32 v10, v10, v20
    v_cvt_pk_bf16_f32 v177, v130, v131
    v_mfma_f32_16x16x32_bf16 a[92:95], a[60:63], v[192:195], a[92:95]
    v_rcp_f32 v10, v10
    v_mfma_f32_16x16x32_bf16 v[24:27], v[28:31], v[196:199], v[24:27]
    v_exp_f32 v138, v138
    v_mfma_f32_16x16x32_bf16 v[32:35], a[32:35], v[196:199], v[32:35]
    v_exp_f32 v139, v139
    v_mfma_f32_16x16x32_bf16 v[36:39], a[36:39], v[196:199], v[36:39]
    v_exp_f32 v140, v140
    v_mfma_f32_16x16x32_bf16 v[40:43], a[40:43], v[196:199], v[40:43]
    v_exp_f32 v141, v141
    v_mfma_f32_16x16x32_bf16 v[44:47], a[44:47], v[196:199], v[44:47]
    v_exp_f32 v142, v142
    v_add_u32 v6, 8192, v17
    v_accvgpr_read_b32 v224, a64
    v_accvgpr_read_b32 v225, a65
    v_accvgpr_read_b32 v226, a66
    v_accvgpr_read_b32 v227, a67
    v_accvgpr_read_b32 v228, a68
    v_accvgpr_read_b32 v229, a69
    v_accvgpr_read_b32 v230, a70
    v_accvgpr_read_b32 v231, a71
    v_pk_mul_f32 v[224:225], v[224:225], v[10:11] op_sel:[0,0] op_sel_hi:[1,0]
    v_pk_mul_f32 v[226:227], v[226:227], v[10:11] op_sel:[0,0] op_sel_hi:[1,0]
    v_pk_mul_f32 v[228:229], v[228:229], v[10:11] op_sel:[0,0] op_sel_hi:[1,0]
    v_pk_mul_f32 v[230:231], v[230:231], v[10:11] op_sel:[0,0] op_sel_hi:[1,0]
    v_cvt_pk_bf16_f32 v232, v224, v225
    v_cvt_pk_bf16_f32 v233, v226, v227
    v_cvt_pk_bf16_f32 v234, v228, v229
    v_cvt_pk_bf16_f32 v235, v230, v231
    v_mfma_f32_16x16x32_bf16 v[48:51], a[48:51], v[196:199], v[48:51]
    v_exp_f32 v143, v143
    v_mfma_f32_16x16x32_bf16 v[52:55], a[52:55], v[196:199], v[52:55]
    v_add_f32 v11, v11, v24
    v_cvt_pk_bf16_f32 v178, v132, v133
    v_mfma_f32_16x16x32_bf16 v[56:59], a[56:59], v[196:199], v[56:59]
    v_rcp_f32 v11, v11
    v_mfma_f32_16x16x32_bf16 v[60:63], a[60:63], v[196:199], v[60:63]
    s_waitcnt lgkmcnt(7)
    ds_write_b64 v15, v[232:233] offset:0
    ds_write_b64 v15, v[234:235] offset:32
    v_cvt_pk_bf16_f32 v179, v134, v135
    v_cvt_pk_bf16_f32 v180, v136, v137
    v_accvgpr_read_b32 v224, a72
    v_accvgpr_read_b32 v225, a73
    v_accvgpr_read_b32 v226, a74
    v_accvgpr_read_b32 v227, a75
    v_accvgpr_read_b32 v228, a76
    v_accvgpr_read_b32 v229, a77
    v_accvgpr_read_b32 v230, a78
    v_accvgpr_read_b32 v231, a79
    v_pk_mul_f32 v[224:225], v[224:225], v[10:11] op_sel:[0,0] op_sel_hi:[1,0]
    v_pk_mul_f32 v[226:227], v[226:227], v[10:11] op_sel:[0,0] op_sel_hi:[1,0]
    v_pk_mul_f32 v[228:229], v[228:229], v[10:11] op_sel:[0,0] op_sel_hi:[1,0]
    v_pk_mul_f32 v[230:231], v[230:231], v[10:11] op_sel:[0,0] op_sel_hi:[1,0]
    v_cvt_pk_bf16_f32 v236, v224, v225
    v_cvt_pk_bf16_f32 v237, v226, v227
    v_cvt_pk_bf16_f32 v238, v228, v229
    v_cvt_pk_bf16_f32 v239, v230, v231
    v_mfma_f32_16x16x32_bf16 v[144:147], a[192:195], a[160:163], v[216:219]
    v_cvt_pk_bf16_f32 v181, v138, v139
    v_cvt_pk_bf16_f32 v182, v140, v141
    v_mfma_f32_16x16x32_bf16 v[152:155], a[192:195], a[176:179], v[220:223]
    s_waitcnt lgkmcnt(8)
    ds_read_b128 a[192:195], v4 offset:60928
    v_cvt_pk_bf16_f32 v183, v142, v143
    v_mfma_f32_16x16x32_bf16 v[144:147], a[196:199], a[164:167], v[144:147]
    ds_write_b64 v15, v[236:237] offset:64
    v_mfma_f32_16x16x32_bf16 v[152:155], a[196:199], a[180:183], v[152:155]
    s_waitcnt lgkmcnt(8)
    ds_read_b128 a[196:199], v4 offset:60992
    ds_write_b64 v15, v[238:239] offset:96
    v_accvgpr_read_b32 v224, a80
    v_accvgpr_read_b32 v225, a81
    v_accvgpr_read_b32 v226, a82
    v_accvgpr_read_b32 v227, a83
    v_accvgpr_read_b32 v228, a84
    v_accvgpr_read_b32 v229, a85
    v_accvgpr_read_b32 v230, a86
    v_accvgpr_read_b32 v231, a87
    v_pk_mul_f32 v[224:225], v[224:225], v[10:11] op_sel:[0,0] op_sel_hi:[1,0]
    v_pk_mul_f32 v[226:227], v[226:227], v[10:11] op_sel:[0,0] op_sel_hi:[1,0]
    v_pk_mul_f32 v[228:229], v[228:229], v[10:11] op_sel:[0,0] op_sel_hi:[1,0]
    v_pk_mul_f32 v[230:231], v[230:231], v[10:11] op_sel:[0,0] op_sel_hi:[1,0]
    v_cvt_pk_bf16_f32 v232, v224, v225
    v_cvt_pk_bf16_f32 v233, v226, v227
    v_cvt_pk_bf16_f32 v234, v228, v229
    v_cvt_pk_bf16_f32 v235, v230, v231
    v_mfma_f32_16x16x32_bf16 v[144:147], a[200:203], a[168:171], v[144:147]
    ds_write_b64 v15, v[232:233] offset:128
    v_mfma_f32_16x16x32_bf16 v[152:155], a[200:203], a[184:187], v[152:155]
    ds_read_b128 a[200:203], v4 offset:61056
    v_accvgpr_read_b32 v224, a88
    v_mfma_f32_16x16x32_bf16 v[144:147], a[204:207], a[172:175], v[144:147]
    ds_write_b64 v15, v[234:235] offset:160
    v_mfma_f32_16x16x32_bf16 v[152:155], a[204:207], a[188:191], v[152:155]
    s_waitcnt lgkmcnt(8)
    ds_read_b128 a[204:207], v4 offset:61120
    v_accvgpr_read_b32 v225, a89
    v_accvgpr_read_b32 v226, a90
    v_accvgpr_read_b32 v227, a91
    v_accvgpr_read_b32 v228, a92
    v_accvgpr_read_b32 v229, a93
    v_accvgpr_read_b32 v230, a94
    v_accvgpr_read_b32 v231, a95
    v_pk_mul_f32 v[224:225], v[224:225], v[10:11] op_sel:[0,0] op_sel_hi:[1,0]
    v_pk_mul_f32 v[226:227], v[226:227], v[10:11] op_sel:[0,0] op_sel_hi:[1,0]
    v_pk_mul_f32 v[228:229], v[228:229], v[10:11] op_sel:[0,0] op_sel_hi:[1,0]
    v_pk_mul_f32 v[230:231], v[230:231], v[10:11] op_sel:[0,0] op_sel_hi:[1,0]
    v_cvt_pk_bf16_f32 v236, v224, v225
    v_cvt_pk_bf16_f32 v237, v226, v227
    v_cvt_pk_bf16_f32 v238, v228, v229
    v_cvt_pk_bf16_f32 v239, v230, v231
    v_mfma_f32_16x16x32_bf16 v[148:151], a[208:211], a[160:163], v[216:219]
    v_mfma_f32_16x16x32_bf16 v[156:159], a[208:211], a[176:179], v[220:223]
    ds_read_b128 a[208:211], v4 offset:65280
    v_mfma_f32_16x16x32_bf16 v[148:151], a[212:215], a[164:167], v[148:151]
    v_exp_f32 v144, v144
    v_mfma_f32_16x16x32_bf16 v[156:159], a[212:215], a[180:183], v[156:159]
    ds_read_b128 a[212:215], v4 offset:65344
    ds_write_b64 v15, v[236:237] offset:192
    ds_write_b64 v15, v[238:239] offset:224
    ds_read_b128 v[240:243], v16 offset:0
    ds_read_b128 v[244:247], v16 offset:1088
    ds_read_b128 v[248:251], v16 offset:2176
    ds_read_b128 v[252:255], v16 offset:3264
    v_mfma_f32_16x16x32_bf16 v[148:151], a[216:219], a[168:171], v[148:151]
    v_exp_f32 v145, v145
    v_add_u32 v7, 12288, v17
    v_mul_f32 v32, v32, v11
    v_mul_f32 v33, v33, v11
    v_pk_mul_f32 v[34:35], v[34:35], v[10:11] op_sel:[0,1] op_sel_hi:[1,1]
    v_pk_mul_f32 v[36:37], v[36:37], v[10:11] op_sel:[0,1] op_sel_hi:[1,1]
    v_pk_mul_f32 v[38:39], v[38:39], v[10:11] op_sel:[0,1] op_sel_hi:[1,1]
    v_cvt_pk_bf16_f32 v232, v32, v33
    v_cvt_pk_bf16_f32 v233, v34, v35
    v_cvt_pk_bf16_f32 v234, v36, v37
    v_cvt_pk_bf16_f32 v235, v38, v39
    v_mfma_f32_16x16x32_bf16 v[156:159], a[216:219], a[184:187], v[156:159]
    ds_read_b128 a[216:219], v4 offset:65408
    v_exp_f32 v146, v146
    v_mfma_f32_16x16x32_bf16 v[148:151], a[220:223], a[172:175], v[148:151]
    v_exp_f32 v147, v147
    v_mfma_f32_16x16x32_bf16 v[156:159], a[220:223], a[188:191], v[156:159]
    ds_read_b128 a[220:223], v4 offset:65472
    v_cvt_pk_bf16_f32 v184, v144, v145
    v_mfma_f32_16x16x32_bf16 v[20:23], v[28:31], v[176:179], 0
    s_waitcnt lgkmcnt(5)
    buffer_store_dwordx4 v[240:243], v6, s[28:31], 0 offen offset:0 sc0 sc1
    ds_write_b64 v15, v[232:233] offset:0
    ds_write_b64 v15, v[234:235] offset:32
    v_exp_f32 v152, v152
    v_pk_mul_f32 v[40:41], v[40:41], v[10:11] op_sel:[0,1] op_sel_hi:[1,1]
    v_pk_mul_f32 v[42:43], v[42:43], v[10:11] op_sel:[0,1] op_sel_hi:[1,1]
    v_pk_mul_f32 v[44:45], v[44:45], v[10:11] op_sel:[0,1] op_sel_hi:[1,1]
    v_pk_mul_f32 v[46:47], v[46:47], v[10:11] op_sel:[0,1] op_sel_hi:[1,1]
    v_cvt_pk_bf16_f32 v236, v40, v41
    v_cvt_pk_bf16_f32 v237, v42, v43
    v_cvt_pk_bf16_f32 v238, v44, v45
    v_cvt_pk_bf16_f32 v239, v46, v47
    v_mfma_f32_16x16x32_bf16 v[64:67], a[32:35], v[176:179], v[64:67]
    v_exp_f32 v153, v153
    v_mfma_f32_16x16x32_bf16 v[68:71], a[36:39], v[176:179], v[68:71]
    s_waitcnt lgkmcnt(6)
    buffer_store_dwordx4 v[244:247], v6, s[28:31], 0 offen offset:1024 sc0 sc1
    v_exp_f32 v148, v148
    v_mfma_f32_16x16x32_bf16 v[72:75], a[40:43], v[176:179], v[72:75]
    v_exp_f32 v149, v149
    v_mfma_f32_16x16x32_bf16 v[76:79], a[44:47], v[176:179], v[76:79]
    s_waitcnt lgkmcnt(5)
    buffer_store_dwordx4 v[248:251], v6, s[28:31], 0 offen offset:2048 sc0 sc1
    ds_write_b64 v15, v[236:237] offset:64
    ds_write_b64 v15, v[238:239] offset:96
    v_exp_f32 v150, v150
    v_pk_mul_f32 v[48:49], v[48:49], v[10:11] op_sel:[0,1] op_sel_hi:[1,1]
    v_pk_mul_f32 v[50:51], v[50:51], v[10:11] op_sel:[0,1] op_sel_hi:[1,1]
    v_pk_mul_f32 v[52:53], v[52:53], v[10:11] op_sel:[0,1] op_sel_hi:[1,1]
    v_pk_mul_f32 v[54:55], v[54:55], v[10:11] op_sel:[0,1] op_sel_hi:[1,1]
    v_cvt_pk_bf16_f32 v232, v48, v49
    v_cvt_pk_bf16_f32 v233, v50, v51
    v_cvt_pk_bf16_f32 v234, v52, v53
    v_cvt_pk_bf16_f32 v235, v54, v55
    v_mfma_f32_16x16x32_bf16 v[80:83], a[48:51], v[176:179], v[80:83]
    v_exp_f32 v151, v151
    v_mfma_f32_16x16x32_bf16 v[84:87], a[52:55], v[176:179], v[84:87]
    s_waitcnt lgkmcnt(6)
    buffer_store_dwordx4 v[252:255], v6, s[28:31], 0 offen offset:3072 sc0 sc1
    v_exp_f32 v154, v154
    v_mfma_f32_16x16x32_bf16 v[88:91], a[56:59], v[176:179], v[88:91]
    v_exp_f32 v155, v155
    v_mfma_f32_16x16x32_bf16 v[92:95], a[60:63], v[176:179], v[92:95]
    ds_write_b64 v15, v[232:233] offset:128
    ds_write_b64 v15, v[234:235] offset:160
    v_exp_f32 v156, v156
    v_pk_mul_f32 v[56:57], v[56:57], v[10:11] op_sel:[0,1] op_sel_hi:[1,1]
    v_pk_mul_f32 v[58:59], v[58:59], v[10:11] op_sel:[0,1] op_sel_hi:[1,1]
    v_pk_mul_f32 v[60:61], v[60:61], v[10:11] op_sel:[0,1] op_sel_hi:[1,1]
    v_pk_mul_f32 v[62:63], v[62:63], v[10:11] op_sel:[0,1] op_sel_hi:[1,1]
    v_cvt_pk_bf16_f32 v236, v56, v57
    v_cvt_pk_bf16_f32 v237, v58, v59
    v_cvt_pk_bf16_f32 v238, v60, v61
    v_cvt_pk_bf16_f32 v239, v62, v63
    v_mfma_f32_16x16x32_bf16 v[160:163], a[192:195], a[160:163], v[216:219]
    v_exp_f32 v157, v157
    v_mfma_f32_16x16x32_bf16 v[168:171], a[192:195], a[176:179], v[220:223]
    v_exp_f32 v158, v158
    v_mfma_f32_16x16x32_bf16 v[160:163], a[196:199], a[164:167], v[160:163]
    v_exp_f32 v159, v159
    v_mfma_f32_16x16x32_bf16 v[168:171], a[196:199], a[180:183], v[168:171]
    ds_write_b64 v15, v[236:237] offset:192
    ds_write_b64 v15, v[238:239] offset:224
    ds_read_b128 v[240:243], v16 offset:0
    ds_read_b128 v[244:247], v16 offset:1088
    ds_read_b128 v[248:251], v16 offset:2176
    ds_read_b128 v[252:255], v16 offset:3264
    v_cvt_pk_bf16_f32 v185, v146, v147
    v_cvt_pk_bf16_f32 v186, v148, v149
    v_mfma_f32_16x16x32_bf16 v[160:163], a[200:203], a[168:171], v[160:163]
    v_cvt_pk_bf16_f32 v187, v150, v151
    v_mov_b32 v14, v12
    v_mfma_f32_16x16x32_bf16 v[168:171], a[200:203], a[184:187], v[168:171]
    s_nop 0
    v_permlane16_swap_b32 v12, v14
    v_mfma_f32_16x16x32_bf16 v[160:163], a[204:207], a[172:175], v[160:163]
    v_cvt_pk_bf16_f32 v188, v152, v153
    v_add_f32 v12, v12, v14
    v_mfma_f32_16x16x32_bf16 v[168:171], a[204:207], a[188:191], v[168:171]
    v_cvt_pk_bf16_f32 v189, v154, v155
    v_mov_b32 v14, v12
    v_mfma_f32_16x16x32_bf16 v[164:167], a[208:211], a[160:163], v[216:219]
    s_waitcnt lgkmcnt(3)
    buffer_store_dwordx4 v[240:243], v7, s[28:31], 0 offen offset:0 sc0 sc1
    v_permlane32_swap_b32 v12, v14
    v_mfma_f32_16x16x32_bf16 v[172:175], a[208:211], a[176:179], v[220:223]
    v_cvt_pk_bf16_f32 v190, v156, v157
    v_add_f32 v12, v12, v14
    v_mfma_f32_16x16x32_bf16 v[164:167], a[212:215], a[164:167], v[164:167]
    s_waitcnt lgkmcnt(2)
    buffer_store_dwordx4 v[244:247], v7, s[28:31], 0 offen offset:1024 sc0 sc1
    v_exp_f32 v160, v160
    v_mfma_f32_16x16x32_bf16 v[172:175], a[212:215], a[180:183], v[172:175]
    v_exp_f32 v161, v161
    v_mfma_f32_16x16x32_bf16 v[164:167], a[216:219], a[168:171], v[164:167]
    s_waitcnt lgkmcnt(1)
    buffer_store_dwordx4 v[248:251], v7, s[28:31], 0 offen offset:2048 sc0 sc1
    v_exp_f32 v162, v162
    v_mfma_f32_16x16x32_bf16 v[172:175], a[216:219], a[184:187], v[172:175]
    v_exp_f32 v163, v163
    v_mfma_f32_16x16x32_bf16 v[164:167], a[220:223], a[172:175], v[164:167]
    s_waitcnt lgkmcnt(0)
    buffer_store_dwordx4 v[252:255], v7, s[28:31], 0 offen offset:3072 sc0 sc1
    v_exp_f32 v168, v168
    v_mfma_f32_16x16x32_bf16 v[172:175], a[220:223], a[188:191], v[172:175]
    v_exp_f32 v169, v169
    v_mfma_f32_16x16x32_bf16 v[20:23], v[28:31], v[184:187], v[20:23]
    v_exp_f32 v170, v170
    v_mfma_f32_16x16x32_bf16 v[64:67], a[0:3], v[184:187], v[64:67]
    v_exp_f32 v171, v171
    v_mfma_f32_16x16x32_bf16 v[68:71], a[4:7], v[184:187], v[68:71]
    v_exp_f32 v164, v164
    v_mfma_f32_16x16x32_bf16 v[72:75], a[8:11], v[184:187], v[72:75]
    v_exp_f32 v165, v165
    v_mfma_f32_16x16x32_bf16 v[76:79], a[12:15], v[184:187], v[76:79]
    v_exp_f32 v166, v166
    v_mfma_f32_16x16x32_bf16 v[80:83], a[16:19], v[184:187], v[80:83]
    v_exp_f32 v167, v167
    v_mfma_f32_16x16x32_bf16 v[84:87], a[20:23], v[184:187], v[84:87]
    v_exp_f32 v172, v172
    v_mfma_f32_16x16x32_bf16 v[88:91], a[24:27], v[184:187], v[88:91]
    v_exp_f32 v173, v173
    v_mfma_f32_16x16x32_bf16 v[92:95], a[28:31], v[184:187], v[92:95]
    v_exp_f32 v174, v174
    v_mfma_f32_16x16x32_bf16 v[24:27], v[28:31], v[180:183], 0
    v_exp_f32 v175, v175
    v_mfma_f32_16x16x32_bf16 v[96:99], a[32:35], v[180:183], v[96:99]
    v_cvt_pk_bf16_f32 v192, v160, v161
    v_cvt_pk_bf16_f32 v193, v162, v163
    v_mfma_f32_16x16x32_bf16 v[100:103], a[36:39], v[180:183], v[100:103]
    v_cvt_pk_bf16_f32 v194, v164, v165
    v_cvt_pk_bf16_f32 v195, v166, v167
    v_mfma_f32_16x16x32_bf16 v[104:107], a[40:43], v[180:183], v[104:107]
    v_cvt_pk_bf16_f32 v191, v158, v159
    v_mov_b32 v2, v13
    v_mfma_f32_16x16x32_bf16 v[108:111], a[44:47], v[180:183], v[108:111]
    s_nop 0
    v_permlane16_swap_b32 v13, v2
    v_mfma_f32_16x16x32_bf16 v[112:115], a[48:51], v[180:183], v[112:115]
    v_cvt_pk_bf16_f32 v196, v168, v169
    v_add_f32 v13, v13, v2
    v_mfma_f32_16x16x32_bf16 v[116:119], a[52:55], v[180:183], v[116:119]
    v_cvt_pk_bf16_f32 v197, v170, v171
    v_cvt_pk_bf16_f32 v198, v172, v173
    v_mfma_f32_16x16x32_bf16 v[120:123], a[56:59], v[180:183], v[120:123]
    v_cvt_pk_bf16_f32 v199, v174, v175
    v_mov_b32 v2, v13
    v_mfma_f32_16x16x32_bf16 v[124:127], a[60:63], v[180:183], v[124:127]
    s_nop 0
    v_permlane32_swap_b32 v13, v2
    v_mfma_f32_16x16x32_bf16 v[20:23], v[28:31], v[192:195], v[20:23]
    v_add_f32 v13, v13, v2
    v_mfma_f32_16x16x32_bf16 v[64:67], a[224:227], v[192:195], v[64:67]
    v_mfma_f32_16x16x32_bf16 v[68:71], a[228:231], v[192:195], v[68:71]
    v_mfma_f32_16x16x32_bf16 v[72:75], a[232:235], v[192:195], v[72:75]
    v_mfma_f32_16x16x32_bf16 v[76:79], a[236:239], v[192:195], v[76:79]
    v_mfma_f32_16x16x32_bf16 v[80:83], a[240:243], v[192:195], v[80:83]
    v_mfma_f32_16x16x32_bf16 v[84:87], a[244:247], v[192:195], v[84:87]
    s_nop 0
    v_add_f32 v12, v12, v20
    v_mfma_f32_16x16x32_bf16 v[88:91], a[248:251], v[192:195], v[88:91]
    v_rcp_f32 v12, v12
    v_mfma_f32_16x16x32_bf16 v[92:95], a[252:255], v[192:195], v[92:95]
    v_mfma_f32_16x16x32_bf16 v[24:27], v[28:31], v[188:191], v[24:27]
    v_mfma_f32_16x16x32_bf16 v[96:99], a[0:3], v[188:191], v[96:99]
    v_mfma_f32_16x16x32_bf16 v[100:103], a[4:7], v[188:191], v[100:103]
    v_mfma_f32_16x16x32_bf16 v[104:107], a[8:11], v[188:191], v[104:107]
    v_mfma_f32_16x16x32_bf16 v[108:111], a[12:15], v[188:191], v[108:111]
    v_add_u32 v6, 16384, v17
    v_mul_f32 v64, v64, v12
    v_mul_f32 v65, v65, v12
    v_mul_f32 v66, v66, v12
    v_mul_f32 v67, v67, v12
    v_pk_mul_f32 v[68:69], v[68:69], v[12:13] op_sel:[0,0] op_sel_hi:[1,0]
    v_pk_mul_f32 v[70:71], v[70:71], v[12:13] op_sel:[0,0] op_sel_hi:[1,0]
    v_cvt_pk_bf16_f32 v232, v64, v65
    v_cvt_pk_bf16_f32 v233, v66, v67
    v_cvt_pk_bf16_f32 v234, v68, v69
    v_cvt_pk_bf16_f32 v235, v70, v71
    v_mfma_f32_16x16x32_bf16 v[112:115], a[16:19], v[188:191], v[112:115]
    ds_write_b64 v15, v[232:233] offset:0
    v_mfma_f32_16x16x32_bf16 v[116:119], a[20:23], v[188:191], v[116:119]
    ds_write_b64 v15, v[234:235] offset:32
    v_mfma_f32_16x16x32_bf16 v[120:123], a[24:27], v[188:191], v[120:123]
    v_mul_f32 v72, v72, v12
    v_mul_f32 v73, v73, v12
    v_mfma_f32_16x16x32_bf16 v[124:127], a[28:31], v[188:191], v[124:127]
    v_mul_f32 v74, v74, v12
    v_mul_f32 v75, v75, v12
    v_mul_f32 v76, v76, v12
    v_mul_f32 v77, v77, v12
    v_mul_f32 v78, v78, v12
    v_mul_f32 v79, v79, v12
    v_cvt_pk_bf16_f32 v236, v72, v73
    v_cvt_pk_bf16_f32 v237, v74, v75
    v_cvt_pk_bf16_f32 v238, v76, v77
    v_cvt_pk_bf16_f32 v239, v78, v79
    v_mfma_f32_16x16x32_bf16 v[24:27], v[28:31], v[196:199], v[24:27]
    ds_write_b64 v15, v[236:237] offset:64
    v_mfma_f32_16x16x32_bf16 v[96:99], a[224:227], v[196:199], v[96:99]
    ds_write_b64 v15, v[238:239] offset:96
    v_mfma_f32_16x16x32_bf16 v[100:103], a[228:231], v[196:199], v[100:103]
    v_mul_f32 v80, v80, v12
    v_mul_f32 v81, v81, v12
    v_mfma_f32_16x16x32_bf16 v[104:107], a[232:235], v[196:199], v[104:107]
    v_mul_f32 v82, v82, v12
    v_mul_f32 v83, v83, v12
    v_mul_f32 v84, v84, v12
    v_mul_f32 v85, v85, v12
    v_mul_f32 v86, v86, v12
    v_mul_f32 v87, v87, v12
    v_cvt_pk_bf16_f32 v232, v80, v81
    v_cvt_pk_bf16_f32 v233, v82, v83
    v_cvt_pk_bf16_f32 v234, v84, v85
    v_cvt_pk_bf16_f32 v235, v86, v87
    v_mfma_f32_16x16x32_bf16 v[108:111], a[236:239], v[196:199], v[108:111]
    ds_write_b64 v15, v[232:233] offset:128
    v_mfma_f32_16x16x32_bf16 v[112:115], a[240:243], v[196:199], v[112:115]
    ds_write_b64 v15, v[234:235] offset:160
    v_mfma_f32_16x16x32_bf16 v[116:119], a[244:247], v[196:199], v[116:119]
    v_add_f32 v13, v13, v24
    v_mul_f32 v88, v88, v12
    v_mfma_f32_16x16x32_bf16 v[120:123], a[248:251], v[196:199], v[120:123]
    v_rcp_f32 v13, v13
    v_mul_f32 v89, v89, v12
    v_mul_f32 v90, v90, v12
    v_mul_f32 v91, v91, v12
    v_pk_mul_f32 v[92:93], v[92:93], v[12:13] op_sel:[0,0] op_sel_hi:[1,0]
    v_pk_mul_f32 v[94:95], v[94:95], v[12:13] op_sel:[0,0] op_sel_hi:[1,0]
    v_cvt_pk_bf16_f32 v236, v88, v89
    v_cvt_pk_bf16_f32 v237, v90, v91
    v_cvt_pk_bf16_f32 v238, v92, v93
    v_cvt_pk_bf16_f32 v239, v94, v95
    v_mfma_f32_16x16x32_bf16 v[124:127], a[252:255], v[196:199], v[124:127]
    ds_write_b64 v15, v[236:237] offset:192
    ds_write_b64 v15, v[238:239] offset:224
    ds_read_b128 v[240:243], v16 offset:0
    ds_read_b128 v[244:247], v16 offset:1088
    ds_read_b128 v[248:251], v16 offset:2176
    ds_read_b128 v[252:255], v16 offset:3264
    v_add_u32 v7, 20480, v17
    v_pk_mul_f32 v[96:97], v[96:97], v[12:13] op_sel:[0,1] op_sel_hi:[1,1]
    v_pk_mul_f32 v[98:99], v[98:99], v[12:13] op_sel:[0,1] op_sel_hi:[1,1]
    v_pk_mul_f32 v[100:101], v[100:101], v[12:13] op_sel:[0,1] op_sel_hi:[1,1]
    v_pk_mul_f32 v[102:103], v[102:103], v[12:13] op_sel:[0,1] op_sel_hi:[1,1]
    v_cvt_pk_bf16_f32 v232, v96, v97
    v_cvt_pk_bf16_f32 v233, v98, v99
    v_cvt_pk_bf16_f32 v234, v100, v101
    v_cvt_pk_bf16_f32 v235, v102, v103
    ds_write_b64 v15, v[232:233] offset:0
    ds_write_b64 v15, v[234:235] offset:32
    s_waitcnt lgkmcnt(5)
    buffer_store_dwordx4 v[240:243], v6, s[28:31], 0 offen offset:0 sc0 sc1
    v_pk_mul_f32 v[104:105], v[104:105], v[12:13] op_sel:[0,1] op_sel_hi:[1,1]
    v_pk_mul_f32 v[106:107], v[106:107], v[12:13] op_sel:[0,1] op_sel_hi:[1,1]
    v_pk_mul_f32 v[108:109], v[108:109], v[12:13] op_sel:[0,1] op_sel_hi:[1,1]
    v_pk_mul_f32 v[110:111], v[110:111], v[12:13] op_sel:[0,1] op_sel_hi:[1,1]
    v_cvt_pk_bf16_f32 v236, v104, v105
    v_cvt_pk_bf16_f32 v237, v106, v107
    v_cvt_pk_bf16_f32 v238, v108, v109
    v_cvt_pk_bf16_f32 v239, v110, v111
    ds_write_b64 v15, v[236:237] offset:64
    ds_write_b64 v15, v[238:239] offset:96
    s_waitcnt lgkmcnt(6)
    buffer_store_dwordx4 v[244:247], v6, s[28:31], 0 offen offset:1024 sc0 sc1
    v_pk_mul_f32 v[112:113], v[112:113], v[12:13] op_sel:[0,1] op_sel_hi:[1,1]
    v_pk_mul_f32 v[114:115], v[114:115], v[12:13] op_sel:[0,1] op_sel_hi:[1,1]
    v_pk_mul_f32 v[116:117], v[116:117], v[12:13] op_sel:[0,1] op_sel_hi:[1,1]
    v_pk_mul_f32 v[118:119], v[118:119], v[12:13] op_sel:[0,1] op_sel_hi:[1,1]
    v_cvt_pk_bf16_f32 v232, v112, v113
    v_cvt_pk_bf16_f32 v233, v114, v115
    v_cvt_pk_bf16_f32 v234, v116, v117
    v_cvt_pk_bf16_f32 v235, v118, v119
    ds_write_b64 v15, v[232:233] offset:128
    ds_write_b64 v15, v[234:235] offset:160
    s_waitcnt lgkmcnt(7)
    buffer_store_dwordx4 v[248:251], v6, s[28:31], 0 offen offset:2048 sc0 sc1
    v_pk_mul_f32 v[120:121], v[120:121], v[12:13] op_sel:[0,1] op_sel_hi:[1,1]
    v_pk_mul_f32 v[122:123], v[122:123], v[12:13] op_sel:[0,1] op_sel_hi:[1,1]
    v_pk_mul_f32 v[124:125], v[124:125], v[12:13] op_sel:[0,1] op_sel_hi:[1,1]
    v_pk_mul_f32 v[126:127], v[126:127], v[12:13] op_sel:[0,1] op_sel_hi:[1,1]
    v_cvt_pk_bf16_f32 v236, v120, v121
    v_cvt_pk_bf16_f32 v237, v122, v123
    v_cvt_pk_bf16_f32 v238, v124, v125
    v_cvt_pk_bf16_f32 v239, v126, v127
    s_waitcnt lgkmcnt(6)
    buffer_store_dwordx4 v[252:255], v6, s[28:31], 0 offen offset:3072 sc0 sc1
    ds_write_b64 v15, v[236:237] offset:192
    ds_write_b64 v15, v[238:239] offset:224
    ds_read_b128 v[240:243], v16 offset:0
    ds_read_b128 v[244:247], v16 offset:1088
    ds_read_b128 v[248:251], v16 offset:2176
    ds_read_b128 v[252:255], v16 offset:3264
    v_min3_f32 v224, v8, v9, v10
    v_min3_f32 v224, v224, v11, v12
    v_min_f32 v224, v224, v13
    v_cmp_ge_f32 vcc, 0x30800000, v224
    s_cmp_lg_u64 vcc, 0
    s_cselect_b32 s57, 1, 0
    s_lshl_b32 s58, s32, 2
    s_add_u32 s58, s58, 154624
    v_mov_b32 v224, s58
    v_mov_b32 v225, s57
    ds_write_b32 v224, v225
    s_waitcnt lgkmcnt(4)
    buffer_store_dwordx4 v[240:243], v7, s[28:31], 0 offen offset:0 sc0 sc1
    s_waitcnt lgkmcnt(3)
    buffer_store_dwordx4 v[244:247], v7, s[28:31], 0 offen offset:1024 sc0 sc1
    s_waitcnt lgkmcnt(2)
    buffer_store_dwordx4 v[248:251], v7, s[28:31], 0 offen offset:2048 sc0 sc1
    s_waitcnt lgkmcnt(1)
    buffer_store_dwordx4 v[252:255], v7, s[28:31], 0 offen offset:3072 sc0 sc1
    s_waitcnt lgkmcnt(0)
    s_barrier
    v_mov_b32 v224, 154624
    ds_read_b128 v[228:231], v224
    s_waitcnt lgkmcnt(0)
    v_or3_b32 v228, v228, v229, v230
    v_or_b32 v228, v228, v231
    s_nop 0
    v_readfirstlane_b32 s57, v228
    s_andn2_b32 s57, s57, s3
    s_cmp_lg_u32 s57, 0
    s_cbranch_scc1 L_exact
L_end:
    s_endpgm

L_exact:
    s_waitcnt vmcnt(0)
    s_barrier
    s_mov_b32 s22, s44
    s_mov_b32 s26, s44
    v_and_b32 v1, 63, v0
    v_lshrrev_b32 v27, 6, v0
    v_lshrrev_b32 v28, 4, v1
    v_and_b32 v29, 15, v1
    v_xor_b32 v21, v28, v29
    v_lshlrev_b32 v20, 8, v28
    v_lshl_add_u32 v24, v21, 4, v20
    v_lshl_add_u32 v2, v27, 11, v24
    v_mul_u32_u24 v22, 24576, v27
    v_add_u32 v14, v22, v24
    v_lshlrev_b32 v20, 11, v28
    v_lshl_add_u32 v20, v27, 9, v20
    v_lshl_add_u32 v3, v29, 4, v20
    v_mov_b32 v6, v4
    v_mov_b32 v8, 0xff7fffff
    v_mov_b32 v9, 0xff7fffff
    v_mov_b32 v10, 0xff7fffff
    v_mov_b32 v11, 0xff7fffff
    v_mov_b32 v12, 0xff7fffff
    v_mov_b32 v13, 0xff7fffff
    s_mov_b32 s40, 0
L_exloop:
    s_mov_b32 m0, s42
    s_nop 0
    buffer_load_dwordx4 v2, s[20:23], s40 offen offset:0 nt lds
    s_add_u32 m0, s42, 64
    s_nop 0
    buffer_load_dwordx4 v2, s[20:23], s40 offen offset:1024 nt lds
    s_waitcnt vmcnt(0)
    s_barrier
    ds_read_b128 a[192:195], v6 offset:0
    ds_read_b128 a[196:199], v6 offset:64
    ds_read_b128 a[200:203], v6 offset:128
    ds_read_b128 a[204:207], v6 offset:192
    ds_read_b128 a[208:211], v6 offset:4352
    ds_read_b128 a[212:215], v6 offset:4416
    ds_read_b128 a[216:219], v6 offset:4480
    ds_read_b128 a[220:223], v6 offset:4544
    s_waitcnt lgkmcnt(0)
    s_barrier
    v_mfma_f32_16x16x32_bf16 v[128:131], a[192:195], a[96:99], 0
    v_mfma_f32_16x16x32_bf16 v[128:131], a[196:199], a[100:103], v[128:131]
    v_mfma_f32_16x16x32_bf16 v[128:131], a[200:203], a[104:107], v[128:131]
    v_mfma_f32_16x16x32_bf16 v[128:131], a[204:207], a[108:111], v[128:131]
    v_mfma_f32_16x16x32_bf16 v[132:135], a[208:211], a[96:99], 0
    v_mfma_f32_16x16x32_bf16 v[132:135], a[212:215], a[100:103], v[132:135]
    v_mfma_f32_16x16x32_bf16 v[132:135], a[216:219], a[104:107], v[132:135]
    v_mfma_f32_16x16x32_bf16 v[132:135], a[220:223], a[108:111], v[132:135]
    v_mfma_f32_16x16x32_bf16 v[136:139], a[192:195], a[112:115], 0
    v_mfma_f32_16x16x32_bf16 v[136:139], a[196:199], a[116:119], v[136:139]
    v_mfma_f32_16x16x32_bf16 v[136:139], a[200:203], a[120:123], v[136:139]
    v_mfma_f32_16x16x32_bf16 v[136:139], a[204:207], a[124:127], v[136:139]
    v_mfma_f32_16x16x32_bf16 v[140:143], a[208:211], a[112:115], 0
    v_mfma_f32_16x16x32_bf16 v[140:143], a[212:215], a[116:119], v[140:143]
    v_mfma_f32_16x16x32_bf16 v[140:143], a[216:219], a[120:123], v[140:143]
    v_mfma_f32_16x16x32_bf16 v[140:143], a[220:223], a[124:127], v[140:143]
    v_mfma_f32_16x16x32_bf16 v[144:147], a[192:195], a[128:131], 0
    v_mfma_f32_16x16x32_bf16 v[144:147], a[196:199], a[132:135], v[144:147]
    v_mfma_f32_16x16x32_bf16 v[144:147], a[200:203], a[136:139], v[144:147]
    v_mfma_f32_16x16x32_bf16 v[144:147], a[204:207], a[140:143], v[144:147]
    v_mfma_f32_16x16x32_bf16 v[148:151], a[208:211], a[128:131], 0
    v_mfma_f32_16x16x32_bf16 v[148:151], a[212:215], a[132:135], v[148:151]
    v_mfma_f32_16x16x32_bf16 v[148:151], a[216:219], a[136:139], v[148:151]
    v_mfma_f32_16x16x32_bf16 v[148:151], a[220:223], a[140:143], v[148:151]
    v_mfma_f32_16x16x32_bf16 v[152:155], a[192:195], a[144:147], 0
    v_mfma_f32_16x16x32_bf16 v[152:155], a[196:199], a[148:151], v[152:155]
    v_mfma_f32_16x16x32_bf16 v[152:155], a[200:203], a[152:155], v[152:155]
    v_mfma_f32_16x16x32_bf16 v[152:155], a[204:207], a[156:159], v[152:155]
    v_mfma_f32_16x16x32_bf16 v[156:159], a[208:211], a[144:147], 0
    v_mfma_f32_16x16x32_bf16 v[156:159], a[212:215], a[148:151], v[156:159]
    v_mfma_f32_16x16x32_bf16 v[156:159], a[216:219], a[152:155], v[156:159]
    v_mfma_f32_16x16x32_bf16 v[156:159], a[220:223], a[156:159], v[156:159]
    v_mfma_f32_16x16x32_bf16 v[160:163], a[192:195], a[160:163], 0
    v_mfma_f32_16x16x32_bf16 v[160:163], a[196:199], a[164:167], v[160:163]
    v_mfma_f32_16x16x32_bf16 v[160:163], a[200:203], a[168:171], v[160:163]
    v_mfma_f32_16x16x32_bf16 v[160:163], a[204:207], a[172:175], v[160:163]
    v_mfma_f32_16x16x32_bf16 v[164:167], a[208:211], a[160:163], 0
    v_mfma_f32_16x16x32_bf16 v[164:167], a[212:215], a[164:167], v[164:167]
    v_mfma_f32_16x16x32_bf16 v[164:167], a[216:219], a[168:171], v[164:167]
    v_mfma_f32_16x16x32_bf16 v[164:167], a[220:223], a[172:175], v[164:167]
    v_mfma_f32_16x16x32_bf16 v[168:171], a[192:195], a[176:179], 0
    v_mfma_f32_16x16x32_bf16 v[168:171], a[196:199], a[180:183], v[168:171]
    v_mfma_f32_16x16x32_bf16 v[168:171], a[200:203], a[184:187], v[168:171]
    v_mfma_f32_16x16x32_bf16 v[168:171], a[204:207], a[188:191], v[168:171]
    v_mfma_f32_16x16x32_bf16 v[172:175], a[208:211], a[176:179], 0
    v_mfma_f32_16x16x32_bf16 v[172:175], a[212:215], a[180:183], v[172:175]
    v_mfma_f32_16x16x32_bf16 v[172:175], a[216:219], a[184:187], v[172:175]
    v_mfma_f32_16x16x32_bf16 v[172:175], a[220:223], a[188:191], v[172:175]
    s_nop 7
    v_max3_f32 v8, v8, v128, v129
    v_max3_f32 v8, v8, v130, v131
    v_max3_f32 v8, v8, v132, v133
    v_max3_f32 v8, v8, v134, v135
    v_max3_f32 v9, v9, v136, v137
    v_max3_f32 v9, v9, v138, v139
    v_max3_f32 v9, v9, v140, v141
    v_max3_f32 v9, v9, v142, v143
    v_max3_f32 v10, v10, v144, v145
    v_max3_f32 v10, v10, v146, v147
    v_max3_f32 v10, v10, v148, v149
    v_max3_f32 v10, v10, v150, v151
    v_max3_f32 v11, v11, v152, v153
    v_max3_f32 v11, v11, v154, v155
    v_max3_f32 v11, v11, v156, v157
    v_max3_f32 v11, v11, v158, v159
    v_max3_f32 v12, v12, v160, v161
    v_max3_f32 v12, v12, v162, v163
    v_max3_f32 v12, v12, v164, v165
    v_max3_f32 v12, v12, v166, v167
    v_max3_f32 v13, v13, v168, v169
    v_max3_f32 v13, v13, v170, v171
    v_max3_f32 v13, v13, v172, v173
    v_max3_f32 v13, v13, v174, v175
    s_add_u32 s40, s40, 8192
    s_cmp_lt_u32 s40, s44
    s_cbranch_scc1 L_exloop
    v_mov_b32 v21, v8
    s_nop 1
    v_permlane16_swap_b32 v8, v21
    v_max_f32 v8, v8, v21
    v_mov_b32 v21, v8
    s_nop 1
    v_permlane32_swap_b32 v8, v21
    v_max_f32 v8, v8, v21
    v_sub_f32 v200, 0, v8
    v_mov_b32 v201, v200
    v_mov_b32 v202, v200
    v_mov_b32 v203, v200
    v_mov_b32 v21, v9
    s_nop 1
    v_permlane16_swap_b32 v9, v21
    v_max_f32 v9, v9, v21
    v_mov_b32 v21, v9
    s_nop 1
    v_permlane32_swap_b32 v9, v21
    v_max_f32 v9, v9, v21
    v_sub_f32 v204, 0, v9
    v_mov_b32 v205, v204
    v_mov_b32 v206, v204
    v_mov_b32 v207, v204
    v_mov_b32 v21, v10
    s_nop 1
    v_permlane16_swap_b32 v10, v21
    v_max_f32 v10, v10, v21
    v_mov_b32 v21, v10
    s_nop 1
    v_permlane32_swap_b32 v10, v21
    v_max_f32 v10, v10, v21
    v_sub_f32 v208, 0, v10
    v_mov_b32 v209, v208
    v_mov_b32 v210, v208
    v_mov_b32 v211, v208
    v_mov_b32 v21, v11
    s_nop 1
    v_permlane16_swap_b32 v11, v21
    v_max_f32 v11, v11, v21
    v_mov_b32 v21, v11
    s_nop 1
    v_permlane32_swap_b32 v11, v21
    v_max_f32 v11, v11, v21
    v_sub_f32 v212, 0, v11
    v_mov_b32 v213, v212
    v_mov_b32 v214, v212
    v_mov_b32 v215, v212
    v_mov_b32 v21, v12
    s_nop 1
    v_permlane16_swap_b32 v12, v21
    v_max_f32 v12, v12, v21
    v_mov_b32 v21, v12
    s_nop 1
    v_permlane32_swap_b32 v12, v21
    v_max_f32 v12, v12, v21
    v_sub_f32 v216, 0, v12
    v_mov_b32 v217, v216
    v_mov_b32 v218, v216
    v_mov_b32 v219, v216
    v_mov_b32 v21, v13
    s_nop 1
    v_permlane16_swap_b32 v13, v21
    v_max_f32 v13, v13, v21
    v_mov_b32 v21, v13
    s_nop 1
    v_permlane32_swap_b32 v13, v21
    v_max_f32 v13, v13, v21
    v_sub_f32 v220, s55, v13
    v_mov_b32 v221, v220
    v_mov_b32 v222, v220
    v_mov_b32 v223, v220
    s_mov_b32 s3, 1
    s_mov_b64 s[100:101], -1
    s_branch L_restart
.section .rodata,"a"
.p2align 6
.amdhsa_kernel standalone__mha_softmax__near_ridge_kernel
  .amdhsa_next_free_vgpr 512
  .amdhsa_next_free_sgpr 102
  .amdhsa_accum_offset 256
  .amdhsa_group_segment_fixed_size 0
  .amdhsa_kernarg_size 48
  .amdhsa_user_sgpr_count 2
  .amdhsa_user_sgpr_kernarg_segment_ptr 1
  .amdhsa_system_sgpr_workgroup_id_x 1
.end_amdhsa_kernel
```
